```python
import torch

def _softmax(x, axis=-1):
    return torch.softmax(x, dim=axis)
def _gelu(x):
    return torch.nn.functional.gelu(x, approximate="tanh")
def _silu(x):
    return torch.nn.functional.silu(x)
def _sigmoid(x):
    return torch.sigmoid(x)
def _layernorm(x, axis=-1, eps=1e-5):
    m = x.mean(dim=axis, keepdim=True)
    v = x.var(dim=axis, keepdim=True, unbiased=False)
    return (x - m) / torch.sqrt(v + eps)
def _scatter_add(tgt, idx, src, axis=0):
    return tgt.clone().index_add_(axis, idx, src)
def _segment_sum(src, seg, n):
    out = torch.zeros((n,) + src.shape[1:], dtype=src.dtype)
    return out.index_add_(0, seg, src)
def _pad(x, pw):
    flat = tuple(v for pair in reversed(pw) for v in pair)
    return torch.nn.functional.pad(x, flat)

kernel_name = 'standalone__molecular_angular_gemnet__graph'

def setup_inputs():

    _w = (lambda a: (lambda t: t.to(torch.bfloat16) if t.is_floating_point() else t)(torch.as_tensor(a)))
    N, deg, De, L = 12500, 32, 4, 1
    E = N * deg
    T = E * deg
    NR = 8
    dist = torch.rand(E).to(float)
    angle = (torch.rand(T) * torch.pi).to(float)
    centers = torch.linspace(0.0, 1.0, NR).to(float)
    ang_freq = torch.arange(1, L + 1).to(float)
    return {
        "m": _w((lambda *s: torch.randn(*s, dtype=torch.bfloat16) * 0.05)(E, De)),
        "idx_in": _w((lambda lo, hi, *s: torch.randint(lo, hi, s))(0, E, T).to(torch.int64)),
        "idx_out": _w((lambda lo, hi, *s: torch.randint(lo, hi, s))(0, E, T).to(torch.int64)),
        "dist": _w(dist),
        "angle": _w(angle),
        "centers": _w(centers),
        "ang_freq": _w(ang_freq),
        "w_rbf": _w((lambda *s: torch.randn(*s, dtype=torch.bfloat16) * 0.4)(NR, De)),
        "w_sbf": _w((lambda *s: torch.randn(*s, dtype=torch.bfloat16) * 0.4)(NR * L, De)),
        "w_down": _w((lambda *s: torch.randn(*s, dtype=torch.bfloat16) * 0.4)(De, De)),
        "w_up": _w((lambda *s: torch.randn(*s, dtype=torch.bfloat16) * 0.4)(De, De)),
    }

def reference(m, idx_in, idx_out, dist, angle, centers, ang_freq, w_rbf, w_sbf, w_down, w_up):
    E, De = m.shape[0], m.shape[1]
    NR = centers.shape[0]
    L = ang_freq.shape[0]
    rbf = torch.exp(-10.0 * (dist[:, None] - centers[None, :]) ** 2)
    cbf = torch.cos(ang_freq[None, :] * angle[:, None])
    rbf_t = rbf[idx_out]
    sbf = torch.reshape(rbf_t[:, :, None] * cbf[:, None, :], (-1, NR * L))
    x = (m[idx_in] @ w_down) * (sbf @ w_sbf)
    agg = _segment_sum(x, idx_out, E)
    return m + (agg @ w_up) * (rbf @ w_rbf)
```

```asm
; @launch kernel=k1_kernel grid=(256,1,1) block=(1024,1,1) lds=163840
; @launch kernel=k2_kernel grid=(256,1,1) block=(1024,1,1) lds=141024
.amdgcn_target "amdgcn-amd-amdhsa--gfx950"
.text
.globl k1_kernel
.p2align 8
.type k1_kernel,@function
k1_kernel:
    s_cmp_ge_u32 s2, 256
    s_cbranch_scc1 k1_done
    s_load_dwordx4 s[28:31], s[0:1], 0
    s_load_dwordx2 s[32:33], s[0:1], 16
    s_load_dwordx2 s[34:35], s[0:1], 32
    s_load_dwordx2 s[36:37], s[0:1], 48
    s_load_dwordx2 s[38:39], s[0:1], 104
    s_load_dwordx2 s[68:69], s[0:1], 24
    s_load_dwordx2 s[66:67], s[0:1], 40
    s_load_dwordx8 s[72:79], s[0:1], 56
    s_getpc_b64 s[60:61]
k1ct_pc:
    s_bfe_u32 s47, s2, 0x30003
    s_lshl_b32 s47, s47, 13
    v_and_b32 v28, 63, v0
    v_lshlrev_b32 v28, 7, v28
    v_add_u32 v28, s47, v28
    v_min_u32 v28, k2_code_end-k1ct_pc-4, v28
    v_mov_b32 v29, s61
    v_add_co_u32 v28, vcc, s60, v28
    v_cmp_gt_u32 s[60:61], 64, v0
    s_nop 0
    v_addc_co_u32 v29, vcc, 0, v29, vcc
    s_and_saveexec_b64 s[60:61], s[60:61]
    s_cbranch_execz k1ct_skip
    global_load_dword v28, v[28:29], off
k1ct_skip:
    s_mov_b64 exec, -1
    v_lshrrev_b32 v6, 6, v0
    v_lshlrev_b32 v3, 4, v0
    v_readfirstlane_b32 s40, v6
    v_mov_b32 v10, 0
    v_mov_b32 v11, 0
    v_mov_b32 v12, 0
    v_mov_b32 v13, 0
    v_lshlrev_b32 v7, 2, v0
    ds_write_b128 v3, v[10:13]
    ds_write_b32 v7, v10 offset:16384
    v_mov_b32 v8, 20544
    ds_write_b64 v8, v[10:11]
    s_mul_i32 s47, s2, 3125
    s_add_u32 s48, s47, 3125
    s_lshr_b32 s47, s47, 2
    s_lshr_b32 s48, s48, 2
    s_sub_u32 s45, s48, s47
    s_lshl_b32 s45, s45, 6
    s_sub_u32 s50, s45, 49152
    v_cmp_gt_u32 s[62:63], s50, v0
    v_mov_b32 v1, 1
    s_mov_b32 s41, 687195
    s_mov_b32 s42, 857622
    s_mov_b32 s43, -6250
    s_mov_b32 s44, -5008
    s_mov_b32 s49, 163776
    s_mov_b32 s53, 5040
    s_lshl_b32 s48, s47, 7
    s_lshl_b32 s47, s47, 8
    s_waitcnt lgkmcnt(0)
    s_barrier
    s_add_u32 s4, s32, s47
    s_addc_u32 s5, s33, 0
    s_mov_b32 s6, 0
    s_mov_b32 s7, 0x00020000
    s_add_u32 s8, s30, s47
    s_addc_u32 s9, s31, 0
    s_mov_b32 s10, 0
    s_mov_b32 s11, 0x00020000
    s_add_u32 s12, s34, s48
    s_addc_u32 s13, s35, 0
    s_mov_b32 s14, 0
    s_mov_b32 s15, 0x00020000
    s_lshl_b32 s6, s45, 2
    s_lshl_b32 s10, s45, 2
    s_lshl_b32 s14, s45, 1
    s_add_u32 s24, s36, 0
    s_addc_u32 s25, s37, 0
    s_mov_b32 s26, 2
    s_mov_b32 s27, 0x00020000
    v_mov_b32 v5, 0
    v_lshrrev_b32 v2, 1, v3
    buffer_load_ushort v5, v5, s[24:27], 0 offen
    s_mov_b32 s47, 0
    buffer_load_dwordx4 v[32:35], v3, s[4:7], s47 offen nt
    buffer_load_dwordx4 v[36:39], v3, s[8:11], s47 offen nt
    s_mov_b32 s48, 0
    buffer_load_dwordx2 v[18:19], v2, s[12:15], s48 offen nt
    s_mov_b32 s47, 16384
    buffer_load_dwordx4 v[40:43], v3, s[4:7], s47 offen nt
    buffer_load_dwordx4 v[44:47], v3, s[8:11], s47 offen nt
    s_mov_b32 s48, 8192
    buffer_load_dwordx2 v[20:21], v2, s[12:15], s48 offen nt
    s_mov_b32 s47, 32768
    buffer_load_dwordx4 v[48:51], v3, s[4:7], s47 offen nt
    buffer_load_dwordx4 v[52:55], v3, s[8:11], s47 offen nt
    s_mov_b32 s48, 16384
    buffer_load_dwordx2 v[22:23], v2, s[12:15], s48 offen nt
    s_mov_b32 s52, 0xffff0000
    s_mul_i32 s47, s2, 321920
    s_add_u32 s16, s38, s47
    s_addc_u32 s17, s39, 0
    s_mov_b32 s18, 321920
    s_mov_b32 s19, 0x00020000
    s_mul_i32 s47, s2, 20496
    s_add_u32 s20, s38, s47
    s_addc_u32 s21, s39, 0
    s_add_u32 s20, s20, 83886080
    s_addc_u32 s21, s21, 0
    s_mov_b32 s22, 20496
    s_mov_b32 s23, 0x00020000
    s_waitcnt vmcnt(7)
    s_mov_b32 s47, 49152
    buffer_load_dwordx4 v[56:59], v3, s[4:7], s47 offen nt
    buffer_load_dwordx4 v[60:63], v3, s[8:11], s47 offen nt
    s_mov_b32 s48, 24576
    buffer_load_dwordx2 v[24:25], v2, s[12:15], s48 offen nt
    v_mul_hi_u32_u24 v6, s41, v32
    v_mul_hi_u32_u24 v7, s42, v36
    v_mad_i32_i24 v32, v6, s43, v32
    v_mul_u32_u24 v6, 80, v6
    v_mad_i32_i24 v36, v7, s44, v36
    v_lshl_add_u32 v10, v7, 2, v6
    v_mul_u32_u24 v7, 205, v7
    v_lshrrev_b32 v7, 12, v7
    v_mad_u32_u24 v10, v7, s53, v10
    ds_add_u32 v10, v1
    v_mul_hi_u32_u24 v6, s41, v33
    v_mul_hi_u32_u24 v7, s42, v37
    v_mad_i32_i24 v8, v6, s43, v33
    v_mul_u32_u24 v6, 80, v6
    v_mad_i32_i24 v37, v7, s44, v37
    v_lshl_add_u32 v11, v7, 2, v6
    v_mul_u32_u24 v7, 205, v7
    v_lshrrev_b32 v7, 12, v7
    v_mad_u32_u24 v11, v7, s53, v11
    ds_add_u32 v11, v1
    v_mul_hi_u32_u24 v6, s41, v34
    v_mul_hi_u32_u24 v7, s42, v38
    v_mad_i32_i24 v34, v6, s43, v34
    v_mul_u32_u24 v6, 80, v6
    v_mad_i32_i24 v38, v7, s44, v38
    v_lshl_add_u32 v12, v7, 2, v6
    v_mul_u32_u24 v7, 205, v7
    v_lshrrev_b32 v7, 12, v7
    v_mad_u32_u24 v12, v7, s53, v12
    ds_add_u32 v12, v1
    v_mul_hi_u32_u24 v6, s41, v35
    v_mul_hi_u32_u24 v7, s42, v39
    v_mad_i32_i24 v9, v6, s43, v35
    v_mul_u32_u24 v6, 80, v6
    v_mad_i32_i24 v39, v7, s44, v39
    v_lshl_add_u32 v13, v7, 2, v6
    v_mul_u32_u24 v7, 205, v7
    v_lshrrev_b32 v7, 12, v7
    v_mad_u32_u24 v13, v7, s53, v13
    ds_add_u32 v13, v1
    v_lshrrev_b32 v6, 10, v36
    v_lshrrev_b32 v7, 10, v37
    v_lshl_or_b32 v32, v32, 3, v6
    v_lshl_or_b32 v33, v36, 22, v10
    v_lshl_or_b32 v36, v8, 3, v7
    v_lshl_or_b32 v37, v37, 22, v11
    v_lshrrev_b32 v6, 10, v38
    v_lshrrev_b32 v7, 10, v39
    v_lshl_or_b32 v34, v34, 3, v6
    v_lshl_or_b32 v35, v38, 22, v12
    v_lshl_or_b32 v38, v9, 3, v7
    v_lshl_or_b32 v39, v39, 22, v13
    s_waitcnt vmcnt(9)
    v_lshlrev_b32 v5, 16, v5
    v_lshlrev_b32 v14, 16, v18
    v_and_b32 v15, 0xffff0000, v18
    v_mul_f32 v14, v5, v14
    v_mul_f32 v15, v5, v15
    v_cvt_pk_bf16_f32 v15, v14, v15
    v_lshlrev_b32 v14, 16, v15
    v_and_b32 v15, 0xffff0000, v15
    v_mul_f32 v14, 0.15915494, v14
    v_mul_f32 v15, 0.15915494, v15
    v_fract_f32 v14, v14
    v_fract_f32 v15, v15
    v_cos_f32 v14, v14
    v_cos_f32 v15, v15
    s_nop 0
    v_cvt_pk_bf16_f32 v14, v14, v15
    v_lshl_or_b32 v32, v14, 16, v32
    v_and_or_b32 v36, v14, s52, v36
    v_lshlrev_b32 v16, 16, v19
    v_and_b32 v17, 0xffff0000, v19
    v_mul_f32 v16, v5, v16
    v_mul_f32 v17, v5, v17
    v_cvt_pk_bf16_f32 v17, v16, v17
    v_lshlrev_b32 v16, 16, v17
    v_and_b32 v17, 0xffff0000, v17
    v_mul_f32 v16, 0.15915494, v16
    v_mul_f32 v17, 0.15915494, v17
    v_fract_f32 v16, v16
    v_fract_f32 v17, v17
    v_cos_f32 v16, v16
    v_cos_f32 v17, v17
    s_nop 0
    v_cvt_pk_bf16_f32 v16, v16, v17
    v_lshl_or_b32 v34, v16, 16, v34
    v_and_or_b32 v38, v16, s52, v38
    s_waitcnt vmcnt(7)
    s_mov_b32 s47, 65536
    buffer_load_dwordx4 v[64:67], v3, s[4:7], s47 offen nt
    buffer_load_dwordx4 v[68:71], v3, s[8:11], s47 offen nt
    v_mul_hi_u32_u24 v6, s41, v40
    v_mul_hi_u32_u24 v7, s42, v44
    v_mad_i32_i24 v40, v6, s43, v40
    v_mul_u32_u24 v6, 80, v6
    v_mad_i32_i24 v44, v7, s44, v44
    v_lshl_add_u32 v10, v7, 2, v6
    v_mul_u32_u24 v7, 205, v7
    v_lshrrev_b32 v7, 12, v7
    v_mad_u32_u24 v10, v7, s53, v10
    ds_add_u32 v10, v1
    v_mul_hi_u32_u24 v6, s41, v41
    v_mul_hi_u32_u24 v7, s42, v45
    v_mad_i32_i24 v8, v6, s43, v41
    v_mul_u32_u24 v6, 80, v6
    v_mad_i32_i24 v45, v7, s44, v45
    v_lshl_add_u32 v11, v7, 2, v6
    v_mul_u32_u24 v7, 205, v7
    v_lshrrev_b32 v7, 12, v7
    v_mad_u32_u24 v11, v7, s53, v11
    ds_add_u32 v11, v1
    v_mul_hi_u32_u24 v6, s41, v42
    v_mul_hi_u32_u24 v7, s42, v46
    v_mad_i32_i24 v42, v6, s43, v42
    v_mul_u32_u24 v6, 80, v6
    v_mad_i32_i24 v46, v7, s44, v46
    v_lshl_add_u32 v12, v7, 2, v6
    v_mul_u32_u24 v7, 205, v7
    v_lshrrev_b32 v7, 12, v7
    v_mad_u32_u24 v12, v7, s53, v12
    ds_add_u32 v12, v1
    v_mul_hi_u32_u24 v6, s41, v43
    v_mul_hi_u32_u24 v7, s42, v47
    v_mad_i32_i24 v9, v6, s43, v43
    v_mul_u32_u24 v6, 80, v6
    v_mad_i32_i24 v47, v7, s44, v47
    v_lshl_add_u32 v13, v7, 2, v6
    v_mul_u32_u24 v7, 205, v7
    v_lshrrev_b32 v7, 12, v7
    v_mad_u32_u24 v13, v7, s53, v13
    ds_add_u32 v13, v1
    v_lshrrev_b32 v6, 10, v44
    v_lshrrev_b32 v7, 10, v45
    v_lshl_or_b32 v40, v40, 3, v6
    v_lshl_or_b32 v41, v44, 22, v10
    v_lshl_or_b32 v44, v8, 3, v7
    v_lshl_or_b32 v45, v45, 22, v11
    v_lshrrev_b32 v6, 10, v46
    v_lshrrev_b32 v7, 10, v47
    v_lshl_or_b32 v42, v42, 3, v6
    v_lshl_or_b32 v43, v46, 22, v12
    v_lshl_or_b32 v46, v9, 3, v7
    v_lshl_or_b32 v47, v47, 22, v13
    s_waitcnt vmcnt(8)
    v_lshlrev_b32 v14, 16, v20
    v_and_b32 v15, 0xffff0000, v20
    v_mul_f32 v14, v5, v14
    v_mul_f32 v15, v5, v15
    v_cvt_pk_bf16_f32 v15, v14, v15
    v_lshlrev_b32 v14, 16, v15
    v_and_b32 v15, 0xffff0000, v15
    v_mul_f32 v14, 0.15915494, v14
    v_mul_f32 v15, 0.15915494, v15
    v_fract_f32 v14, v14
    v_fract_f32 v15, v15
    v_cos_f32 v14, v14
    v_cos_f32 v15, v15
    s_nop 0
    v_cvt_pk_bf16_f32 v14, v14, v15
    v_lshl_or_b32 v40, v14, 16, v40
    v_and_or_b32 v44, v14, s52, v44
    v_lshlrev_b32 v16, 16, v21
    v_and_b32 v17, 0xffff0000, v21
    v_mul_f32 v16, v5, v16
    v_mul_f32 v17, v5, v17
    v_cvt_pk_bf16_f32 v17, v16, v17
    v_lshlrev_b32 v16, 16, v17
    v_and_b32 v17, 0xffff0000, v17
    v_mul_f32 v16, 0.15915494, v16
    v_mul_f32 v17, 0.15915494, v17
    v_fract_f32 v16, v16
    v_fract_f32 v17, v17
    v_cos_f32 v16, v16
    v_cos_f32 v17, v17
    s_nop 0
    v_cvt_pk_bf16_f32 v16, v16, v17
    v_lshl_or_b32 v42, v16, 16, v42
    v_and_or_b32 v46, v16, s52, v46
    s_waitcnt vmcnt(6)
    s_mov_b32 s47, 81920
    buffer_load_dwordx4 v[72:75], v3, s[4:7], s47 offen nt
    buffer_load_dwordx4 v[76:79], v3, s[8:11], s47 offen nt
    s_add_u32 s24, s28, 0
    s_addc_u32 s25, s29, 0
    s_mov_b32 s26, 3200000
    s_mov_b32 s27, 0x00020000
    s_mul_i32 s47, s2, 12512
    v_add_u32 v6, s47, v3
    v_mov_b32 v8, 782
    v_cmp_lt_u32 s[64:65], v0, v8
    v_mov_b32 v8, 0xffff0000
    s_mul_i32 s47, s2, 3200
    v_cndmask_b32 v6, v8, v6, s[64:65]
    buffer_load_dwordx4 v[120:123], v6, s[24:27], 0 offen
    v_min_u32 v7, 24, v0
    v_lshlrev_b32 v7, 7, v7
    v_add_u32 v7, s47, v7
    s_mov_b32 s70, 800000
    s_mov_b32 s71, 0x00020000
    buffer_load_dword v29, v7, s[68:71], 0 offen
    s_load_dword s60, s[66:67], 0
    s_load_dword s61, s[72:73], 0
    s_load_dword s60, s[74:75], 0
    s_load_dword s61, s[76:77], 0
    s_load_dword s60, s[78:79], 0
    v_mul_hi_u32_u24 v6, s41, v48
    v_mul_hi_u32_u24 v7, s42, v52
    v_mad_i32_i24 v48, v6, s43, v48
    v_mul_u32_u24 v6, 80, v6
    v_mad_i32_i24 v52, v7, s44, v52
    v_lshl_add_u32 v10, v7, 2, v6
    v_mul_u32_u24 v7, 205, v7
    v_lshrrev_b32 v7, 12, v7
    v_mad_u32_u24 v10, v7, s53, v10
    ds_add_u32 v10, v1
    v_mul_hi_u32_u24 v6, s41, v49
    v_mul_hi_u32_u24 v7, s42, v53
    v_mad_i32_i24 v8, v6, s43, v49
    v_mul_u32_u24 v6, 80, v6
    v_mad_i32_i24 v53, v7, s44, v53
    v_lshl_add_u32 v11, v7, 2, v6
    v_mul_u32_u24 v7, 205, v7
    v_lshrrev_b32 v7, 12, v7
    v_mad_u32_u24 v11, v7, s53, v11
    ds_add_u32 v11, v1
    v_mul_hi_u32_u24 v6, s41, v50
    v_mul_hi_u32_u24 v7, s42, v54
    v_mad_i32_i24 v50, v6, s43, v50
    v_mul_u32_u24 v6, 80, v6
    v_mad_i32_i24 v54, v7, s44, v54
    v_lshl_add_u32 v12, v7, 2, v6
    v_mul_u32_u24 v7, 205, v7
    v_lshrrev_b32 v7, 12, v7
    v_mad_u32_u24 v12, v7, s53, v12
    ds_add_u32 v12, v1
    v_mul_hi_u32_u24 v6, s41, v51
    v_mul_hi_u32_u24 v7, s42, v55
    v_mad_i32_i24 v9, v6, s43, v51
    v_mul_u32_u24 v6, 80, v6
    v_mad_i32_i24 v55, v7, s44, v55
    v_lshl_add_u32 v13, v7, 2, v6
    v_mul_u32_u24 v7, 205, v7
    v_lshrrev_b32 v7, 12, v7
    v_mad_u32_u24 v13, v7, s53, v13
    ds_add_u32 v13, v1
    v_lshrrev_b32 v6, 10, v52
    v_lshrrev_b32 v7, 10, v53
    v_lshl_or_b32 v48, v48, 3, v6
    v_lshl_or_b32 v49, v52, 22, v10
    v_lshl_or_b32 v52, v8, 3, v7
    v_lshl_or_b32 v53, v53, 22, v11
    v_lshrrev_b32 v6, 10, v54
    v_lshrrev_b32 v7, 10, v55
    v_lshl_or_b32 v50, v50, 3, v6
    v_lshl_or_b32 v51, v54, 22, v12
    v_lshl_or_b32 v54, v9, 3, v7
    v_lshl_or_b32 v55, v55, 22, v13
    s_waitcnt vmcnt(9)
    v_lshlrev_b32 v14, 16, v22
    v_and_b32 v15, 0xffff0000, v22
    v_mul_f32 v14, v5, v14
    v_mul_f32 v15, v5, v15
    v_cvt_pk_bf16_f32 v15, v14, v15
    v_lshlrev_b32 v14, 16, v15
    v_and_b32 v15, 0xffff0000, v15
    v_mul_f32 v14, 0.15915494, v14
    v_mul_f32 v15, 0.15915494, v15
    v_fract_f32 v14, v14
    v_fract_f32 v15, v15
    v_cos_f32 v14, v14
    v_cos_f32 v15, v15
    s_nop 0
    v_cvt_pk_bf16_f32 v14, v14, v15
    v_lshl_or_b32 v48, v14, 16, v48
    v_and_or_b32 v52, v14, s52, v52
    v_lshlrev_b32 v16, 16, v23
    v_and_b32 v17, 0xffff0000, v23
    v_mul_f32 v16, v5, v16
    v_mul_f32 v17, v5, v17
    v_cvt_pk_bf16_f32 v17, v16, v17
    v_lshlrev_b32 v16, 16, v17
    v_and_b32 v17, 0xffff0000, v17
    v_mul_f32 v16, 0.15915494, v16
    v_mul_f32 v17, 0.15915494, v17
    v_fract_f32 v16, v16
    v_fract_f32 v17, v17
    v_cos_f32 v16, v16
    v_cos_f32 v17, v17
    s_nop 0
    v_cvt_pk_bf16_f32 v16, v16, v17
    v_lshl_or_b32 v50, v16, 16, v50
    v_and_or_b32 v54, v16, s52, v54
    s_waitcnt vmcnt(7)
    s_mov_b32 s47, 98304
    buffer_load_dwordx4 v[80:83], v3, s[4:7], s47 offen nt
    buffer_load_dwordx4 v[84:87], v3, s[8:11], s47 offen nt
    v_mul_hi_u32_u24 v6, s41, v56
    v_mul_hi_u32_u24 v7, s42, v60
    v_mad_i32_i24 v56, v6, s43, v56
    v_mul_u32_u24 v6, 80, v6
    v_mad_i32_i24 v60, v7, s44, v60
    v_lshl_add_u32 v10, v7, 2, v6
    v_mul_u32_u24 v7, 205, v7
    v_lshrrev_b32 v7, 12, v7
    v_mad_u32_u24 v10, v7, s53, v10
    ds_add_u32 v10, v1
    v_mul_hi_u32_u24 v6, s41, v57
    v_mul_hi_u32_u24 v7, s42, v61
    v_mad_i32_i24 v8, v6, s43, v57
    v_mul_u32_u24 v6, 80, v6
    v_mad_i32_i24 v61, v7, s44, v61
    v_lshl_add_u32 v11, v7, 2, v6
    v_mul_u32_u24 v7, 205, v7
    v_lshrrev_b32 v7, 12, v7
    v_mad_u32_u24 v11, v7, s53, v11
    ds_add_u32 v11, v1
    v_mul_hi_u32_u24 v6, s41, v58
    v_mul_hi_u32_u24 v7, s42, v62
    v_mad_i32_i24 v58, v6, s43, v58
    v_mul_u32_u24 v6, 80, v6
    v_mad_i32_i24 v62, v7, s44, v62
    v_lshl_add_u32 v12, v7, 2, v6
    v_mul_u32_u24 v7, 205, v7
    v_lshrrev_b32 v7, 12, v7
    v_mad_u32_u24 v12, v7, s53, v12
    ds_add_u32 v12, v1
    v_mul_hi_u32_u24 v6, s41, v59
    v_mul_hi_u32_u24 v7, s42, v63
    v_mad_i32_i24 v9, v6, s43, v59
    v_mul_u32_u24 v6, 80, v6
    v_mad_i32_i24 v63, v7, s44, v63
    v_lshl_add_u32 v13, v7, 2, v6
    v_mul_u32_u24 v7, 205, v7
    v_lshrrev_b32 v7, 12, v7
    v_mad_u32_u24 v13, v7, s53, v13
    ds_add_u32 v13, v1
    v_lshrrev_b32 v6, 10, v60
    v_lshrrev_b32 v7, 10, v61
    v_lshl_or_b32 v56, v56, 3, v6
    v_lshl_or_b32 v57, v60, 22, v10
    v_lshl_or_b32 v60, v8, 3, v7
    v_lshl_or_b32 v61, v61, 22, v11
    v_lshrrev_b32 v6, 10, v62
    v_lshrrev_b32 v7, 10, v63
    v_lshl_or_b32 v58, v58, 3, v6
    v_lshl_or_b32 v59, v62, 22, v12
    v_lshl_or_b32 v62, v9, 3, v7
    v_lshl_or_b32 v63, v63, 22, v13
    s_waitcnt vmcnt(8)
    v_lshlrev_b32 v14, 16, v24
    v_and_b32 v15, 0xffff0000, v24
    v_mul_f32 v14, v5, v14
    v_mul_f32 v15, v5, v15
    v_cvt_pk_bf16_f32 v15, v14, v15
    v_lshlrev_b32 v14, 16, v15
    v_and_b32 v15, 0xffff0000, v15
    v_mul_f32 v14, 0.15915494, v14
    v_mul_f32 v15, 0.15915494, v15
    v_fract_f32 v14, v14
    v_fract_f32 v15, v15
    v_cos_f32 v14, v14
    v_cos_f32 v15, v15
    s_nop 0
    v_cvt_pk_bf16_f32 v14, v14, v15
    v_lshl_or_b32 v56, v14, 16, v56
    v_and_or_b32 v60, v14, s52, v60
    v_lshlrev_b32 v16, 16, v25
    v_and_b32 v17, 0xffff0000, v25
    v_mul_f32 v16, v5, v16
    v_mul_f32 v17, v5, v17
    v_cvt_pk_bf16_f32 v17, v16, v17
    v_lshlrev_b32 v16, 16, v17
    v_and_b32 v17, 0xffff0000, v17
    v_mul_f32 v16, 0.15915494, v16
    v_mul_f32 v17, 0.15915494, v17
    v_fract_f32 v16, v16
    v_fract_f32 v17, v17
    v_cos_f32 v16, v16
    v_cos_f32 v17, v17
    s_nop 0
    v_cvt_pk_bf16_f32 v16, v16, v17
    v_lshl_or_b32 v58, v16, 16, v58
    v_and_or_b32 v62, v16, s52, v62
    s_waitcnt vmcnt(6)
    s_mov_b32 s47, 114688
    buffer_load_dwordx4 v[88:91], v3, s[4:7], s47 offen nt
    buffer_load_dwordx4 v[92:95], v3, s[8:11], s47 offen nt
    v_mul_hi_u32_u24 v6, s41, v64
    v_mul_hi_u32_u24 v7, s42, v68
    v_mad_i32_i24 v64, v6, s43, v64
    v_mul_u32_u24 v6, 80, v6
    v_mad_i32_i24 v68, v7, s44, v68
    v_lshl_add_u32 v10, v7, 2, v6
    v_mul_u32_u24 v7, 205, v7
    v_lshrrev_b32 v7, 12, v7
    v_mad_u32_u24 v10, v7, s53, v10
    ds_add_u32 v10, v1
    v_mul_hi_u32_u24 v6, s41, v65
    v_mul_hi_u32_u24 v7, s42, v69
    v_mad_i32_i24 v8, v6, s43, v65
    v_mul_u32_u24 v6, 80, v6
    v_mad_i32_i24 v69, v7, s44, v69
    v_lshl_add_u32 v11, v7, 2, v6
    v_mul_u32_u24 v7, 205, v7
    v_lshrrev_b32 v7, 12, v7
    v_mad_u32_u24 v11, v7, s53, v11
    ds_add_u32 v11, v1
    v_mul_hi_u32_u24 v6, s41, v66
    v_mul_hi_u32_u24 v7, s42, v70
    v_mad_i32_i24 v66, v6, s43, v66
    v_mul_u32_u24 v6, 80, v6
    v_mad_i32_i24 v70, v7, s44, v70
    v_lshl_add_u32 v12, v7, 2, v6
    v_mul_u32_u24 v7, 205, v7
    v_lshrrev_b32 v7, 12, v7
    v_mad_u32_u24 v12, v7, s53, v12
    ds_add_u32 v12, v1
    v_mul_hi_u32_u24 v6, s41, v67
    v_mul_hi_u32_u24 v7, s42, v71
    v_mad_i32_i24 v9, v6, s43, v67
    v_mul_u32_u24 v6, 80, v6
    v_mad_i32_i24 v71, v7, s44, v71
    v_lshl_add_u32 v13, v7, 2, v6
    v_mul_u32_u24 v7, 205, v7
    v_lshrrev_b32 v7, 12, v7
    v_mad_u32_u24 v13, v7, s53, v13
    ds_add_u32 v13, v1
    v_lshrrev_b32 v6, 10, v68
    v_lshrrev_b32 v7, 10, v69
    v_lshl_or_b32 v64, v64, 3, v6
    v_lshl_or_b32 v65, v68, 22, v10
    v_lshl_or_b32 v68, v8, 3, v7
    v_lshl_or_b32 v69, v69, 22, v11
    v_lshrrev_b32 v6, 10, v70
    v_lshrrev_b32 v7, 10, v71
    v_lshl_or_b32 v66, v66, 3, v6
    v_lshl_or_b32 v67, v70, 22, v12
    v_lshl_or_b32 v70, v9, 3, v7
    v_lshl_or_b32 v71, v71, 22, v13
    s_waitcnt vmcnt(6)
    s_mov_b32 s47, 131072
    buffer_load_dwordx4 v[96:99], v3, s[4:7], s47 offen nt
    buffer_load_dwordx4 v[100:103], v3, s[8:11], s47 offen nt
    v_mul_hi_u32_u24 v6, s41, v72
    v_mul_hi_u32_u24 v7, s42, v76
    v_mad_i32_i24 v72, v6, s43, v72
    v_mul_u32_u24 v6, 80, v6
    v_mad_i32_i24 v76, v7, s44, v76
    v_lshl_add_u32 v10, v7, 2, v6
    v_mul_u32_u24 v7, 205, v7
    v_lshrrev_b32 v7, 12, v7
    v_mad_u32_u24 v10, v7, s53, v10
    ds_add_u32 v10, v1
    v_mul_hi_u32_u24 v6, s41, v73
    v_mul_hi_u32_u24 v7, s42, v77
    v_mad_i32_i24 v8, v6, s43, v73
    v_mul_u32_u24 v6, 80, v6
    v_mad_i32_i24 v77, v7, s44, v77
    v_lshl_add_u32 v11, v7, 2, v6
    v_mul_u32_u24 v7, 205, v7
    v_lshrrev_b32 v7, 12, v7
    v_mad_u32_u24 v11, v7, s53, v11
    ds_add_u32 v11, v1
    v_mul_hi_u32_u24 v6, s41, v74
    v_mul_hi_u32_u24 v7, s42, v78
    v_mad_i32_i24 v74, v6, s43, v74
    v_mul_u32_u24 v6, 80, v6
    v_mad_i32_i24 v78, v7, s44, v78
    v_lshl_add_u32 v12, v7, 2, v6
    v_mul_u32_u24 v7, 205, v7
    v_lshrrev_b32 v7, 12, v7
    v_mad_u32_u24 v12, v7, s53, v12
    ds_add_u32 v12, v1
    v_mul_hi_u32_u24 v6, s41, v75
    v_mul_hi_u32_u24 v7, s42, v79
    v_mad_i32_i24 v9, v6, s43, v75
    v_mul_u32_u24 v6, 80, v6
    v_mad_i32_i24 v79, v7, s44, v79
    v_lshl_add_u32 v13, v7, 2, v6
    v_mul_u32_u24 v7, 205, v7
    v_lshrrev_b32 v7, 12, v7
    v_mad_u32_u24 v13, v7, s53, v13
    ds_add_u32 v13, v1
    v_lshrrev_b32 v6, 10, v76
    v_lshrrev_b32 v7, 10, v77
    v_lshl_or_b32 v72, v72, 3, v6
    v_lshl_or_b32 v73, v76, 22, v10
    v_lshl_or_b32 v76, v8, 3, v7
    v_lshl_or_b32 v77, v77, 22, v11
    v_lshrrev_b32 v6, 10, v78
    v_lshrrev_b32 v7, 10, v79
    v_lshl_or_b32 v74, v74, 3, v6
    v_lshl_or_b32 v75, v78, 22, v12
    v_lshl_or_b32 v78, v9, 3, v7
    v_lshl_or_b32 v79, v79, 22, v13
    s_waitcnt vmcnt(7)
    v_and_b32 v120, 0x7fff7fff, v120
    v_and_b32 v121, 0x7fff7fff, v121
    v_and_b32 v122, 0x7fff7fff, v122
    v_and_b32 v123, 0x7fff7fff, v123
    v_pk_max_u16 v6, v120, v121
    v_pk_max_u16 v7, v122, v123
    v_pk_max_u16 v6, v6, v7
    v_lshrrev_b32 v7, 16, v6
    v_and_b32 v6, 0xffff, v6
    v_max_u32 v6, v6, v7
    v_mov_b32 v7, 0
    v_lshlrev_b32 v8, 16, v120
    v_and_b32 v9, 0xffff0000, v120
    v_add_f32 v7, v7, v8
    v_add_f32 v7, v7, v9
    v_lshlrev_b32 v8, 16, v121
    v_and_b32 v9, 0xffff0000, v121
    v_add_f32 v7, v7, v8
    v_add_f32 v7, v7, v9
    v_lshlrev_b32 v8, 16, v122
    v_and_b32 v9, 0xffff0000, v122
    v_add_f32 v7, v7, v8
    v_add_f32 v7, v7, v9
    v_lshlrev_b32 v8, 16, v123
    v_and_b32 v9, 0xffff0000, v123
    v_add_f32 v7, v7, v8
    v_add_f32 v7, v7, v9
    v_mov_b32 v8, 20544
    v_max_u32_dpp v6, v6, v6 row_shr:1 row_mask:0xf bank_mask:0xf
    s_nop 1
    v_max_u32_dpp v6, v6, v6 row_shr:2 row_mask:0xf bank_mask:0xf
    s_nop 1
    v_max_u32_dpp v6, v6, v6 row_shr:4 row_mask:0xf bank_mask:0xf
    s_nop 1
    v_max_u32_dpp v6, v6, v6 row_shr:8 row_mask:0xf bank_mask:0xf
    s_nop 1
    v_max_u32_dpp v6, v6, v6 row_bcast:15 row_mask:0xa bank_mask:0xf
    s_nop 1
    v_max_u32_dpp v6, v6, v6 row_bcast:31 row_mask:0xc bank_mask:0xf
    s_nop 1
    v_add_f32_dpp v7, v7, v7 row_shr:1 row_mask:0xf bank_mask:0xf
    s_nop 1
    v_add_f32_dpp v7, v7, v7 row_shr:2 row_mask:0xf bank_mask:0xf
    s_nop 1
    v_add_f32_dpp v7, v7, v7 row_shr:4 row_mask:0xf bank_mask:0xf
    s_nop 1
    v_add_f32_dpp v7, v7, v7 row_shr:8 row_mask:0xf bank_mask:0xf
    s_nop 1
    v_add_f32_dpp v7, v7, v7 row_bcast:15 row_mask:0xa bank_mask:0xf
    s_nop 1
    v_add_f32_dpp v7, v7, v7 row_bcast:31 row_mask:0xc bank_mask:0xf
    s_nop 1
    s_mov_b32 exec_lo, 0
    s_mov_b32 exec_hi, 0x80000000
    ds_max_u32 v8, v6
    ds_add_f32 v8, v7 offset:4
    s_mov_b64 exec, -1
    s_waitcnt vmcnt(4)
    s_mov_b32 s47, 147456
    buffer_load_dwordx4 v[104:107], v3, s[4:7], s47 offen nt
    buffer_load_dwordx4 v[108:111], v3, s[8:11], s47 offen nt
    v_mul_hi_u32_u24 v6, s41, v80
    v_mul_hi_u32_u24 v7, s42, v84
    v_mad_i32_i24 v80, v6, s43, v80
    v_mul_u32_u24 v6, 80, v6
    v_mad_i32_i24 v84, v7, s44, v84
    v_lshl_add_u32 v10, v7, 2, v6
    v_mul_u32_u24 v7, 205, v7
    v_lshrrev_b32 v7, 12, v7
    v_mad_u32_u24 v10, v7, s53, v10
    ds_add_u32 v10, v1
    v_mul_hi_u32_u24 v6, s41, v81
    v_mul_hi_u32_u24 v7, s42, v85
    v_mad_i32_i24 v8, v6, s43, v81
    v_mul_u32_u24 v6, 80, v6
    v_mad_i32_i24 v85, v7, s44, v85
    v_lshl_add_u32 v11, v7, 2, v6
    v_mul_u32_u24 v7, 205, v7
    v_lshrrev_b32 v7, 12, v7
    v_mad_u32_u24 v11, v7, s53, v11
    ds_add_u32 v11, v1
    v_mul_hi_u32_u24 v6, s41, v82
    v_mul_hi_u32_u24 v7, s42, v86
    v_mad_i32_i24 v82, v6, s43, v82
    v_mul_u32_u24 v6, 80, v6
    v_mad_i32_i24 v86, v7, s44, v86
    v_lshl_add_u32 v12, v7, 2, v6
    v_mul_u32_u24 v7, 205, v7
    v_lshrrev_b32 v7, 12, v7
    v_mad_u32_u24 v12, v7, s53, v12
    ds_add_u32 v12, v1
    v_mul_hi_u32_u24 v6, s41, v83
    v_mul_hi_u32_u24 v7, s42, v87
    v_mad_i32_i24 v9, v6, s43, v83
    v_mul_u32_u24 v6, 80, v6
    v_mad_i32_i24 v87, v7, s44, v87
    v_lshl_add_u32 v13, v7, 2, v6
    v_mul_u32_u24 v7, 205, v7
    v_lshrrev_b32 v7, 12, v7
    v_mad_u32_u24 v13, v7, s53, v13
    ds_add_u32 v13, v1
    v_lshrrev_b32 v6, 10, v84
    v_lshrrev_b32 v7, 10, v85
    v_lshl_or_b32 v80, v80, 3, v6
    v_lshl_or_b32 v81, v84, 22, v10
    v_lshl_or_b32 v84, v8, 3, v7
    v_lshl_or_b32 v85, v85, 22, v11
    v_lshrrev_b32 v6, 10, v86
    v_lshrrev_b32 v7, 10, v87
    v_lshl_or_b32 v82, v82, 3, v6
    v_lshl_or_b32 v83, v86, 22, v12
    v_lshl_or_b32 v86, v9, 3, v7
    v_lshl_or_b32 v87, v87, 22, v13
    s_waitcnt vmcnt(4)
    s_mov_b32 s47, 163840
    buffer_load_dwordx4 v[112:115], v3, s[4:7], s47 offen nt
    buffer_load_dwordx4 v[116:119], v3, s[8:11], s47 offen nt
    v_mul_hi_u32_u24 v6, s41, v88
    v_mul_hi_u32_u24 v7, s42, v92
    v_mad_i32_i24 v88, v6, s43, v88
    v_mul_u32_u24 v6, 80, v6
    v_mad_i32_i24 v92, v7, s44, v92
    v_lshl_add_u32 v10, v7, 2, v6
    v_mul_u32_u24 v7, 205, v7
    v_lshrrev_b32 v7, 12, v7
    v_mad_u32_u24 v10, v7, s53, v10
    ds_add_u32 v10, v1
    v_mul_hi_u32_u24 v6, s41, v89
    v_mul_hi_u32_u24 v7, s42, v93
    v_mad_i32_i24 v8, v6, s43, v89
    v_mul_u32_u24 v6, 80, v6
    v_mad_i32_i24 v93, v7, s44, v93
    v_lshl_add_u32 v11, v7, 2, v6
    v_mul_u32_u24 v7, 205, v7
    v_lshrrev_b32 v7, 12, v7
    v_mad_u32_u24 v11, v7, s53, v11
    ds_add_u32 v11, v1
    v_mul_hi_u32_u24 v6, s41, v90
    v_mul_hi_u32_u24 v7, s42, v94
    v_mad_i32_i24 v90, v6, s43, v90
    v_mul_u32_u24 v6, 80, v6
    v_mad_i32_i24 v94, v7, s44, v94
    v_lshl_add_u32 v12, v7, 2, v6
    v_mul_u32_u24 v7, 205, v7
    v_lshrrev_b32 v7, 12, v7
    v_mad_u32_u24 v12, v7, s53, v12
    ds_add_u32 v12, v1
    v_mul_hi_u32_u24 v6, s41, v91
    v_mul_hi_u32_u24 v7, s42, v95
    v_mad_i32_i24 v9, v6, s43, v91
    v_mul_u32_u24 v6, 80, v6
    v_mad_i32_i24 v95, v7, s44, v95
    v_lshl_add_u32 v13, v7, 2, v6
    v_mul_u32_u24 v7, 205, v7
    v_lshrrev_b32 v7, 12, v7
    v_mad_u32_u24 v13, v7, s53, v13
    ds_add_u32 v13, v1
    v_lshrrev_b32 v6, 10, v92
    v_lshrrev_b32 v7, 10, v93
    v_lshl_or_b32 v88, v88, 3, v6
    v_lshl_or_b32 v89, v92, 22, v10
    v_lshl_or_b32 v92, v8, 3, v7
    v_lshl_or_b32 v93, v93, 22, v11
    v_lshrrev_b32 v6, 10, v94
    v_lshrrev_b32 v7, 10, v95
    v_lshl_or_b32 v90, v90, 3, v6
    v_lshl_or_b32 v91, v94, 22, v12
    v_lshl_or_b32 v94, v9, 3, v7
    v_lshl_or_b32 v95, v95, 22, v13
    s_waitcnt vmcnt(4)
    s_mov_b32 s47, 180224
    buffer_load_dwordx4 v[120:123], v3, s[4:7], s47 offen nt
    buffer_load_dwordx4 v[124:127], v3, s[8:11], s47 offen nt
    v_mul_hi_u32_u24 v6, s41, v96
    v_mul_hi_u32_u24 v7, s42, v100
    v_mad_i32_i24 v96, v6, s43, v96
    v_mul_u32_u24 v6, 80, v6
    v_mad_i32_i24 v100, v7, s44, v100
    v_lshl_add_u32 v10, v7, 2, v6
    v_mul_u32_u24 v7, 205, v7
    v_lshrrev_b32 v7, 12, v7
    v_mad_u32_u24 v10, v7, s53, v10
    ds_add_u32 v10, v1
    v_mul_hi_u32_u24 v6, s41, v97
    v_mul_hi_u32_u24 v7, s42, v101
    v_mad_i32_i24 v8, v6, s43, v97
    v_mul_u32_u24 v6, 80, v6
    v_mad_i32_i24 v101, v7, s44, v101
    v_lshl_add_u32 v11, v7, 2, v6
    v_mul_u32_u24 v7, 205, v7
    v_lshrrev_b32 v7, 12, v7
    v_mad_u32_u24 v11, v7, s53, v11
    ds_add_u32 v11, v1
    v_mul_hi_u32_u24 v6, s41, v98
    v_mul_hi_u32_u24 v7, s42, v102
    v_mad_i32_i24 v98, v6, s43, v98
    v_mul_u32_u24 v6, 80, v6
    v_mad_i32_i24 v102, v7, s44, v102
    v_lshl_add_u32 v12, v7, 2, v6
    v_mul_u32_u24 v7, 205, v7
    v_lshrrev_b32 v7, 12, v7
    v_mad_u32_u24 v12, v7, s53, v12
    ds_add_u32 v12, v1
    v_mul_hi_u32_u24 v6, s41, v99
    v_mul_hi_u32_u24 v7, s42, v103
    v_mad_i32_i24 v9, v6, s43, v99
    v_mul_u32_u24 v6, 80, v6
    v_mad_i32_i24 v103, v7, s44, v103
    v_lshl_add_u32 v13, v7, 2, v6
    v_mul_u32_u24 v7, 205, v7
    v_lshrrev_b32 v7, 12, v7
    v_mad_u32_u24 v13, v7, s53, v13
    ds_add_u32 v13, v1
    v_lshrrev_b32 v6, 10, v100
    v_lshrrev_b32 v7, 10, v101
    v_lshl_or_b32 v96, v96, 3, v6
    v_lshl_or_b32 v97, v100, 22, v10
    v_lshl_or_b32 v100, v8, 3, v7
    v_lshl_or_b32 v101, v101, 22, v11
    v_lshrrev_b32 v6, 10, v102
    v_lshrrev_b32 v7, 10, v103
    v_lshl_or_b32 v98, v98, 3, v6
    v_lshl_or_b32 v99, v102, 22, v12
    v_lshl_or_b32 v102, v9, 3, v7
    v_lshl_or_b32 v103, v103, 22, v13
    s_waitcnt vmcnt(4)
    v_lshrrev_b32 v27, 2, v3
    v_add_u32 v27, 196608, v27
    buffer_load_dword v30, v27, s[4:7], 0 offen nt
    buffer_load_dword v31, v27, s[8:11], 0 offen nt
    v_lshrrev_b32 v27, 1, v27
    buffer_load_ushort v27, v27, s[12:15], 0 offen nt
    v_mul_hi_u32_u24 v6, s41, v104
    v_mul_hi_u32_u24 v7, s42, v108
    v_mad_i32_i24 v104, v6, s43, v104
    v_mul_u32_u24 v6, 80, v6
    v_mad_i32_i24 v108, v7, s44, v108
    v_lshl_add_u32 v10, v7, 2, v6
    v_mul_u32_u24 v7, 205, v7
    v_lshrrev_b32 v7, 12, v7
    v_mad_u32_u24 v10, v7, s53, v10
    ds_add_u32 v10, v1
    v_mul_hi_u32_u24 v6, s41, v105
    v_mul_hi_u32_u24 v7, s42, v109
    v_mad_i32_i24 v8, v6, s43, v105
    v_mul_u32_u24 v6, 80, v6
    v_mad_i32_i24 v109, v7, s44, v109
    v_lshl_add_u32 v11, v7, 2, v6
    v_mul_u32_u24 v7, 205, v7
    v_lshrrev_b32 v7, 12, v7
    v_mad_u32_u24 v11, v7, s53, v11
    ds_add_u32 v11, v1
    v_mul_hi_u32_u24 v6, s41, v106
    v_mul_hi_u32_u24 v7, s42, v110
    v_mad_i32_i24 v106, v6, s43, v106
    v_mul_u32_u24 v6, 80, v6
    v_mad_i32_i24 v110, v7, s44, v110
    v_lshl_add_u32 v12, v7, 2, v6
    v_mul_u32_u24 v7, 205, v7
    v_lshrrev_b32 v7, 12, v7
    v_mad_u32_u24 v12, v7, s53, v12
    ds_add_u32 v12, v1
    v_mul_hi_u32_u24 v6, s41, v107
    v_mul_hi_u32_u24 v7, s42, v111
    v_mad_i32_i24 v9, v6, s43, v107
    v_mul_u32_u24 v6, 80, v6
    v_mad_i32_i24 v111, v7, s44, v111
    v_lshl_add_u32 v13, v7, 2, v6
    v_mul_u32_u24 v7, 205, v7
    v_lshrrev_b32 v7, 12, v7
    v_mad_u32_u24 v13, v7, s53, v13
    ds_add_u32 v13, v1
    v_lshrrev_b32 v6, 10, v108
    v_lshrrev_b32 v7, 10, v109
    v_lshl_or_b32 v104, v104, 3, v6
    v_lshl_or_b32 v105, v108, 22, v10
    v_lshl_or_b32 v108, v8, 3, v7
    v_lshl_or_b32 v109, v109, 22, v11
    v_lshrrev_b32 v6, 10, v110
    v_lshrrev_b32 v7, 10, v111
    v_lshl_or_b32 v106, v106, 3, v6
    v_lshl_or_b32 v107, v110, 22, v12
    v_lshl_or_b32 v110, v9, 3, v7
    v_lshl_or_b32 v111, v111, 22, v13
    s_waitcnt vmcnt(5)
    v_mul_hi_u32_u24 v6, s41, v112
    v_mul_hi_u32_u24 v7, s42, v116
    v_mad_i32_i24 v112, v6, s43, v112
    v_mul_u32_u24 v6, 80, v6
    v_mad_i32_i24 v116, v7, s44, v116
    v_lshl_add_u32 v10, v7, 2, v6
    v_mul_u32_u24 v7, 205, v7
    v_lshrrev_b32 v7, 12, v7
    v_mad_u32_u24 v10, v7, s53, v10
    ds_add_u32 v10, v1
    v_mul_hi_u32_u24 v6, s41, v113
    v_mul_hi_u32_u24 v7, s42, v117
    v_mad_i32_i24 v8, v6, s43, v113
    v_mul_u32_u24 v6, 80, v6
    v_mad_i32_i24 v117, v7, s44, v117
    v_lshl_add_u32 v11, v7, 2, v6
    v_mul_u32_u24 v7, 205, v7
    v_lshrrev_b32 v7, 12, v7
    v_mad_u32_u24 v11, v7, s53, v11
    ds_add_u32 v11, v1
    v_mul_hi_u32_u24 v6, s41, v114
    v_mul_hi_u32_u24 v7, s42, v118
    v_mad_i32_i24 v114, v6, s43, v114
    v_mul_u32_u24 v6, 80, v6
    v_mad_i32_i24 v118, v7, s44, v118
    v_lshl_add_u32 v12, v7, 2, v6
    v_mul_u32_u24 v7, 205, v7
    v_lshrrev_b32 v7, 12, v7
    v_mad_u32_u24 v12, v7, s53, v12
    ds_add_u32 v12, v1
    v_mul_hi_u32_u24 v6, s41, v115
    v_mul_hi_u32_u24 v7, s42, v119
    v_mad_i32_i24 v9, v6, s43, v115
    v_mul_u32_u24 v6, 80, v6
    v_mad_i32_i24 v119, v7, s44, v119
    v_lshl_add_u32 v13, v7, 2, v6
    v_mul_u32_u24 v7, 205, v7
    v_lshrrev_b32 v7, 12, v7
    v_mad_u32_u24 v13, v7, s53, v13
    ds_add_u32 v13, v1
    v_lshrrev_b32 v6, 10, v116
    v_lshrrev_b32 v7, 10, v117
    v_lshl_or_b32 v112, v112, 3, v6
    v_lshl_or_b32 v113, v116, 22, v10
    v_lshl_or_b32 v116, v8, 3, v7
    v_lshl_or_b32 v117, v117, 22, v11
    v_lshrrev_b32 v6, 10, v118
    v_lshrrev_b32 v7, 10, v119
    v_lshl_or_b32 v114, v114, 3, v6
    v_lshl_or_b32 v115, v118, 22, v12
    v_lshl_or_b32 v118, v9, 3, v7
    v_lshl_or_b32 v119, v119, 22, v13
    s_waitcnt vmcnt(3)
    v_mul_hi_u32_u24 v6, s41, v120
    v_mul_hi_u32_u24 v7, s42, v124
    v_mad_i32_i24 v120, v6, s43, v120
    v_mul_u32_u24 v6, 80, v6
    v_mad_i32_i24 v124, v7, s44, v124
    v_lshl_add_u32 v10, v7, 2, v6
    v_mul_u32_u24 v7, 205, v7
    v_lshrrev_b32 v7, 12, v7
    v_mad_u32_u24 v10, v7, s53, v10
    ds_add_u32 v10, v1
    v_mul_hi_u32_u24 v6, s41, v121
    v_mul_hi_u32_u24 v7, s42, v125
    v_mad_i32_i24 v8, v6, s43, v121
    v_mul_u32_u24 v6, 80, v6
    v_mad_i32_i24 v125, v7, s44, v125
    v_lshl_add_u32 v11, v7, 2, v6
    v_mul_u32_u24 v7, 205, v7
    v_lshrrev_b32 v7, 12, v7
    v_mad_u32_u24 v11, v7, s53, v11
    ds_add_u32 v11, v1
    v_mul_hi_u32_u24 v6, s41, v122
    v_mul_hi_u32_u24 v7, s42, v126
    v_mad_i32_i24 v122, v6, s43, v122
    v_mul_u32_u24 v6, 80, v6
    v_mad_i32_i24 v126, v7, s44, v126
    v_lshl_add_u32 v12, v7, 2, v6
    v_mul_u32_u24 v7, 205, v7
    v_lshrrev_b32 v7, 12, v7
    v_mad_u32_u24 v12, v7, s53, v12
    ds_add_u32 v12, v1
    v_mul_hi_u32_u24 v6, s41, v123
    v_mul_hi_u32_u24 v7, s42, v127
    v_mad_i32_i24 v9, v6, s43, v123
    v_mul_u32_u24 v6, 80, v6
    v_mad_i32_i24 v127, v7, s44, v127
    v_lshl_add_u32 v13, v7, 2, v6
    v_mul_u32_u24 v7, 205, v7
    v_lshrrev_b32 v7, 12, v7
    v_mad_u32_u24 v13, v7, s53, v13
    ds_add_u32 v13, v1
    v_lshrrev_b32 v6, 10, v124
    v_lshrrev_b32 v7, 10, v125
    v_lshl_or_b32 v120, v120, 3, v6
    v_lshl_or_b32 v121, v124, 22, v10
    v_lshl_or_b32 v124, v8, 3, v7
    v_lshl_or_b32 v125, v125, 22, v11
    v_lshrrev_b32 v6, 10, v126
    v_lshrrev_b32 v7, 10, v127
    v_lshl_or_b32 v122, v122, 3, v6
    v_lshl_or_b32 v123, v126, 22, v12
    v_lshl_or_b32 v126, v9, 3, v7
    v_lshl_or_b32 v127, v127, 22, v13
    s_waitcnt vmcnt(1)
    v_mul_hi_u32_u24 v6, s41, v30
    v_mul_hi_u32_u24 v7, s42, v31
    v_mad_i32_i24 v30, v6, s43, v30
    v_mul_u32_u24 v6, 80, v6
    v_mad_i32_i24 v31, v7, s44, v31
    v_lshl_add_u32 v10, v7, 2, v6
    v_mul_u32_u24 v7, 205, v7
    v_lshrrev_b32 v7, 12, v7
    v_mad_u32_u24 v10, v7, s53, v10
    s_mov_b64 exec, s[62:63]
    ds_add_u32 v10, v1
    s_mov_b64 exec, -1
    v_lshrrev_b32 v6, 10, v31
    v_lshl_or_b32 v30, v30, 3, v6
    v_lshl_or_b32 v31, v31, 22, v10
    s_mov_b32 s48, 32768
    buffer_load_dwordx2 v[18:19], v2, s[12:15], s48 offen nt
    s_mov_b32 s48, 40960
    buffer_load_dwordx2 v[20:21], v2, s[12:15], s48 offen nt
    s_mov_b32 s48, 49152
    buffer_load_dwordx2 v[22:23], v2, s[12:15], s48 offen nt
    s_mov_b32 s48, 57344
    buffer_load_dwordx2 v[24:25], v2, s[12:15], s48 offen nt
    s_waitcnt lgkmcnt(0)
    s_barrier
    v_mul_u32_u24 v2, 20, v0
    ds_read_b32 v6, v2 offset:0
    ds_read_b32 v7, v2 offset:4
    ds_read_b32 v8, v2 offset:8
    ds_read_b32 v9, v2 offset:12
    ds_read_b32 v10, v2 offset:16
    s_mov_b32 s47, 43691
    s_waitcnt lgkmcnt(0)
    v_add_u32 v12, 2, v6
    v_mul_u32_u24 v12, s47, v12
    v_lshrrev_b32 v12, 17, v12
    v_add_u32 v13, 2, v7
    v_mul_u32_u24 v13, s47, v13
    v_lshrrev_b32 v13, 17, v13
    v_add_u32 v14, 2, v8
    v_mul_u32_u24 v14, s47, v14
    v_lshrrev_b32 v14, 17, v14
    v_add_u32 v15, 2, v9
    v_mul_u32_u24 v15, s47, v15
    v_lshrrev_b32 v15, 17, v15
    v_add_u32 v16, 2, v10
    v_mul_u32_u24 v16, s47, v16
    v_lshrrev_b32 v16, 17, v16
    v_add3_u32 v4, v12, v13, v14
    v_add3_u32 v4, v4, v15, v16
    v_mov_b32 v1, v4
    s_lshl_b32 s47, s40, 2
    s_add_u32 s47, s47, 20480
    v_add_u32_dpp v1, v1, v1 row_shr:1 row_mask:0xf bank_mask:0xf
    s_nop 1
    v_add_u32_dpp v1, v1, v1 row_shr:2 row_mask:0xf bank_mask:0xf
    s_nop 1
    v_add_u32_dpp v1, v1, v1 row_shr:4 row_mask:0xf bank_mask:0xf
    s_nop 1
    v_add_u32_dpp v1, v1, v1 row_shr:8 row_mask:0xf bank_mask:0xf
    s_nop 1
    v_add_u32_dpp v1, v1, v1 row_bcast:15 row_mask:0xa bank_mask:0xf
    s_nop 1
    v_add_u32_dpp v1, v1, v1 row_bcast:31 row_mask:0xc bank_mask:0xf
    s_nop 1
    v_mov_b32 v17, s47
    s_mov_b32 exec_lo, 0
    s_mov_b32 exec_hi, 0x80000000
    ds_write_b32 v17, v1
    s_mov_b64 exec, -1
    v_mul_u32_u24 v11, 3, v12
    v_sub_u32 v11, v11, v6
    v_min_u32 v6, 0x1fff, v6
    v_lshl_or_b32 v6, v6, 19, v11
    v_mul_u32_u24 v11, 3, v13
    v_sub_u32 v11, v11, v7
    v_min_u32 v7, 0x1fff, v7
    v_lshl_or_b32 v7, v7, 19, v11
    v_mul_u32_u24 v11, 3, v14
    v_sub_u32 v11, v11, v8
    v_min_u32 v8, 0x1fff, v8
    v_lshl_or_b32 v8, v8, 19, v11
    v_mul_u32_u24 v11, 3, v15
    v_sub_u32 v11, v11, v9
    v_min_u32 v9, 0x1fff, v9
    v_lshl_or_b32 v9, v9, 19, v11
    v_mul_u32_u24 v11, 3, v16
    v_sub_u32 v11, v11, v10
    v_min_u32 v10, 0x1fff, v10
    v_lshl_or_b32 v10, v10, 19, v11
    v_sub_u32 v1, v1, v4
    v_and_b32 v17, 15, v0
    v_lshlrev_b32 v17, 2, v17
    v_readfirstlane_b32 s46, v5
    s_waitcnt lgkmcnt(0)
    s_barrier
    ds_read_b32 v17, v17 offset:20480
    v_mov_b32 v28, 20544
    ds_read_b64 v[28:29], v28
    s_waitcnt lgkmcnt(0)
    v_mov_b32 v4, v17
    v_and_b32 v29, 0xffff0000, v29
    v_or_b32 v28, v28, v29
    v_add_u32_dpp v17, v17, v17 row_shr:1 row_mask:0xf bank_mask:0xf
    s_nop 1
    v_add_u32_dpp v17, v17, v17 row_shr:2 row_mask:0xf bank_mask:0xf
    s_nop 1
    v_add_u32_dpp v17, v17, v17 row_shr:4 row_mask:0xf bank_mask:0xf
    s_nop 1
    v_add_u32_dpp v17, v17, v17 row_shr:8 row_mask:0xf bank_mask:0xf
    s_nop 1
    v_readlane_b32 s45, v17, 15
    v_sub_u32 v4, v17, v4
    s_nop 0
    v_readlane_b32 s47, v4, s40
    s_nop 1
    v_add_u32 v1, s47, v1
    v_mul_u32_u24 v17, 24, v1
    v_lshl_or_b32 v6, v1, 4, v6
    ds_write_b32 v2, v17 offset:0
    v_add_u32 v1, v1, v12
    v_mul_u32_u24 v4, 24, v1
    v_lshl_or_b32 v7, v1, 4, v7
    ds_write_b32 v2, v4 offset:4
    v_add_u32 v1, v1, v13
    v_mul_u32_u24 v17, 24, v1
    v_lshl_or_b32 v8, v1, 4, v8
    ds_write_b32 v2, v17 offset:8
    v_add_u32 v1, v1, v14
    v_mul_u32_u24 v4, 24, v1
    v_lshl_or_b32 v9, v1, 4, v9
    ds_write_b32 v2, v4 offset:12
    v_add_u32 v1, v1, v15
    v_mul_u32_u24 v17, 24, v1
    v_lshl_or_b32 v10, v1, 4, v10
    ds_write_b32 v2, v17 offset:16
    v_add_u32 v1, v1, v16
    v_lshlrev_b32 v11, 4, v1
    buffer_store_dwordx4 v[6:9], v2, s[20:23], 0 offen
    buffer_store_dword v10, v2, s[20:23], 0 offen offset:16
    v_mov_b32 v17, 1023
    v_cmp_eq_u32 s[28:29], v0, v17
    v_mov_b32 v1, 8
    v_mov_b32 v17, 0xffff0000
    v_cndmask_b32 v2, v17, v2, s[28:29]
    buffer_store_dword v11, v2, s[20:23], 0 offen offset:20
    v_mov_b32 v4, 0x3fffff
    v_lshrrev_b32 v2, 1, v3
    s_mov_b32 s50, 143040
    s_min_u32 s45, s45, 20096
    s_add_u32 s68, s38, 89194496
    s_addc_u32 s69, s39, 0
    s_mov_b32 s70, 24576
    s_mov_b32 s71, 0x00020000
    s_lshl_b32 s47, s2, 5
    s_add_u32 s47, s47, 16384
    s_lshl_b32 s48, s2, 2
    v_cmp_eq_u32 s[28:29], 8, v0
    v_cmp_gt_u32 s[30:31], 9, v0
    v_lshl_add_u32 v29, v0, 2, s47
    v_mov_b32 v12, s48
    v_cndmask_b32 v28, 0, v28, s[28:29]
    v_cndmask_b32 v29, v29, v12, s[28:29]
    v_cndmask_b32 v29, v17, v29, s[30:31]
    buffer_store_dword v28, v29, s[68:71], 0 offen
    s_waitcnt lgkmcnt(0)
    s_barrier
    s_cmp_lg_u32 s46, 0x3f800000
    s_cbranch_scc1 k1_gen
    v_and_b32 v6, v4, v31
    v_cndmask_b32 v6, v4, v6, s[62:63]
    s_mov_b64 exec, s[62:63]
    ds_add_rtn_u32 v6, v6, v1
    s_mov_b64 exec, -1
    v_and_b32 v10, v4, v65
    ds_add_rtn_u32 v10, v10, v1
    v_and_b32 v11, v4, v69
    ds_add_rtn_u32 v11, v11, v1
    v_and_b32 v12, v4, v67
    ds_add_rtn_u32 v12, v12, v1
    v_and_b32 v13, v4, v71
    ds_add_rtn_u32 v13, v13, v1
    s_waitcnt vmcnt(8)
    v_lshlrev_b32 v14, 16, v27
    v_and_b32 v15, 0xffff0000, v27
    v_mul_f32 v14, 0.15915494, v14
    v_mul_f32 v15, 0.15915494, v15
    v_fract_f32 v14, v14
    v_fract_f32 v15, v15
    v_cos_f32 v14, v14
    v_cos_f32 v15, v15
    s_nop 0
    v_cvt_pk_bf16_f32 v14, v14, v15
    v_lshl_or_b32 v30, v14, 16, v30
    v_and_or_b32 v29, v14, s52, v29
    s_waitcnt lgkmcnt(4)
    v_bitop3_b32 v31, v4, v6, v31 bitop3:0xca
    v_cmpx_gt_u32 vcc, s50, v6
    ds_write_b64 v6, v[30:31] offset:20736
    s_mov_b64 exec, -1
    v_and_b32 v6, v4, v73
    ds_add_rtn_u32 v6, v6, v1
    v_and_b32 v7, v4, v77
    ds_add_rtn_u32 v7, v7, v1
    v_and_b32 v8, v4, v75
    ds_add_rtn_u32 v8, v8, v1
    v_and_b32 v9, v4, v79
    ds_add_rtn_u32 v9, v9, v1
    s_waitcnt vmcnt(7)
    v_lshlrev_b32 v14, 16, v18
    v_and_b32 v15, 0xffff0000, v18
    v_mul_f32 v14, 0.15915494, v14
    v_mul_f32 v15, 0.15915494, v15
    v_fract_f32 v14, v14
    v_fract_f32 v15, v15
    v_cos_f32 v14, v14
    v_cos_f32 v15, v15
    s_nop 0
    v_cvt_pk_bf16_f32 v14, v14, v15
    v_lshl_or_b32 v64, v14, 16, v64
    v_and_or_b32 v68, v14, s52, v68
    v_lshlrev_b32 v16, 16, v19
    v_and_b32 v17, 0xffff0000, v19
    v_mul_f32 v16, 0.15915494, v16
    v_mul_f32 v17, 0.15915494, v17
    v_fract_f32 v16, v16
    v_fract_f32 v17, v17
    v_cos_f32 v16, v16
    v_cos_f32 v17, v17
    s_nop 0
    v_cvt_pk_bf16_f32 v16, v16, v17
    v_lshl_or_b32 v66, v16, 16, v66
    v_and_or_b32 v70, v16, s52, v70
    s_mov_b32 s48, 65536
    buffer_load_dwordx2 v[18:19], v2, s[12:15], s48 offen nt
    s_waitcnt lgkmcnt(4)
    v_bitop3_b32 v65, v4, v10, v65 bitop3:0xca
    v_bitop3_b32 v69, v4, v11, v69 bitop3:0xca
    v_bitop3_b32 v67, v4, v12, v67 bitop3:0xca
    v_bitop3_b32 v71, v4, v13, v71 bitop3:0xca
    v_cmpx_gt_u32 vcc, s50, v10
    ds_write_b64 v10, v[64:65] offset:20736
    s_mov_b64 exec, -1
    v_cmpx_gt_u32 vcc, s50, v11
    ds_write_b64 v11, v[68:69] offset:20736
    s_mov_b64 exec, -1
    v_cmpx_gt_u32 vcc, s50, v12
    ds_write_b64 v12, v[66:67] offset:20736
    s_mov_b64 exec, -1
    v_cmpx_gt_u32 vcc, s50, v13
    ds_write_b64 v13, v[70:71] offset:20736
    s_mov_b64 exec, -1
    v_and_b32 v10, v4, v81
    ds_add_rtn_u32 v10, v10, v1
    v_and_b32 v11, v4, v85
    ds_add_rtn_u32 v11, v11, v1
    v_and_b32 v12, v4, v83
    ds_add_rtn_u32 v12, v12, v1
    v_and_b32 v13, v4, v87
    ds_add_rtn_u32 v13, v13, v1
    s_waitcnt vmcnt(7)
    v_lshlrev_b32 v14, 16, v20
    v_and_b32 v15, 0xffff0000, v20
    v_mul_f32 v14, 0.15915494, v14
    v_mul_f32 v15, 0.15915494, v15
    v_fract_f32 v14, v14
    v_fract_f32 v15, v15
    v_cos_f32 v14, v14
    v_cos_f32 v15, v15
    s_nop 0
    v_cvt_pk_bf16_f32 v14, v14, v15
    v_lshl_or_b32 v72, v14, 16, v72
    v_and_or_b32 v76, v14, s52, v76
    v_lshlrev_b32 v16, 16, v21
    v_and_b32 v17, 0xffff0000, v21
    v_mul_f32 v16, 0.15915494, v16
    v_mul_f32 v17, 0.15915494, v17
    v_fract_f32 v16, v16
    v_fract_f32 v17, v17
    v_cos_f32 v16, v16
    v_cos_f32 v17, v17
    s_nop 0
    v_cvt_pk_bf16_f32 v16, v16, v17
    v_lshl_or_b32 v74, v16, 16, v74
    v_and_or_b32 v78, v16, s52, v78
    s_mov_b32 s48, 73728
    buffer_load_dwordx2 v[20:21], v2, s[12:15], s48 offen nt
    s_waitcnt lgkmcnt(4)
    v_bitop3_b32 v73, v4, v6, v73 bitop3:0xca
    v_bitop3_b32 v77, v4, v7, v77 bitop3:0xca
    v_bitop3_b32 v75, v4, v8, v75 bitop3:0xca
    v_bitop3_b32 v79, v4, v9, v79 bitop3:0xca
    v_cmpx_gt_u32 vcc, s50, v6
    ds_write_b64 v6, v[72:73] offset:20736
    s_mov_b64 exec, -1
    v_cmpx_gt_u32 vcc, s50, v7
    ds_write_b64 v7, v[76:77] offset:20736
    s_mov_b64 exec, -1
    v_cmpx_gt_u32 vcc, s50, v8
    ds_write_b64 v8, v[74:75] offset:20736
    s_mov_b64 exec, -1
    v_cmpx_gt_u32 vcc, s50, v9
    ds_write_b64 v9, v[78:79] offset:20736
    s_mov_b64 exec, -1
    v_and_b32 v6, v4, v89
    ds_add_rtn_u32 v6, v6, v1
    v_and_b32 v7, v4, v93
    ds_add_rtn_u32 v7, v7, v1
    v_and_b32 v8, v4, v91
    ds_add_rtn_u32 v8, v8, v1
    v_and_b32 v9, v4, v95
    ds_add_rtn_u32 v9, v9, v1
    s_waitcnt vmcnt(7)
    v_lshlrev_b32 v14, 16, v22
    v_and_b32 v15, 0xffff0000, v22
    v_mul_f32 v14, 0.15915494, v14
    v_mul_f32 v15, 0.15915494, v15
    v_fract_f32 v14, v14
    v_fract_f32 v15, v15
    v_cos_f32 v14, v14
    v_cos_f32 v15, v15
    s_nop 0
    v_cvt_pk_bf16_f32 v14, v14, v15
    v_lshl_or_b32 v80, v14, 16, v80
    v_and_or_b32 v84, v14, s52, v84
    v_lshlrev_b32 v16, 16, v23
    v_and_b32 v17, 0xffff0000, v23
    v_mul_f32 v16, 0.15915494, v16
    v_mul_f32 v17, 0.15915494, v17
    v_fract_f32 v16, v16
    v_fract_f32 v17, v17
    v_cos_f32 v16, v16
    v_cos_f32 v17, v17
    s_nop 0
    v_cvt_pk_bf16_f32 v16, v16, v17
    v_lshl_or_b32 v82, v16, 16, v82
    v_and_or_b32 v86, v16, s52, v86
    s_mov_b32 s48, 81920
    buffer_load_dwordx2 v[22:23], v2, s[12:15], s48 offen nt
    s_waitcnt lgkmcnt(4)
    v_bitop3_b32 v81, v4, v10, v81 bitop3:0xca
    v_bitop3_b32 v85, v4, v11, v85 bitop3:0xca
    v_bitop3_b32 v83, v4, v12, v83 bitop3:0xca
    v_bitop3_b32 v87, v4, v13, v87 bitop3:0xca
    v_cmpx_gt_u32 vcc, s50, v10
    ds_write_b64 v10, v[80:81] offset:20736
    s_mov_b64 exec, -1
    v_cmpx_gt_u32 vcc, s50, v11
    ds_write_b64 v11, v[84:85] offset:20736
    s_mov_b64 exec, -1
    v_cmpx_gt_u32 vcc, s50, v12
    ds_write_b64 v12, v[82:83] offset:20736
    s_mov_b64 exec, -1
    v_cmpx_gt_u32 vcc, s50, v13
    ds_write_b64 v13, v[86:87] offset:20736
    s_mov_b64 exec, -1
    v_and_b32 v10, v4, v33
    ds_add_rtn_u32 v10, v10, v1
    v_and_b32 v11, v4, v37
    ds_add_rtn_u32 v11, v11, v1
    v_and_b32 v12, v4, v35
    ds_add_rtn_u32 v12, v12, v1
    v_and_b32 v13, v4, v39
    ds_add_rtn_u32 v13, v13, v1
    s_waitcnt vmcnt(7)
    v_lshlrev_b32 v14, 16, v24
    v_and_b32 v15, 0xffff0000, v24
    v_mul_f32 v14, 0.15915494, v14
    v_mul_f32 v15, 0.15915494, v15
    v_fract_f32 v14, v14
    v_fract_f32 v15, v15
    v_cos_f32 v14, v14
    v_cos_f32 v15, v15
    s_nop 0
    v_cvt_pk_bf16_f32 v14, v14, v15
    v_lshl_or_b32 v88, v14, 16, v88
    v_and_or_b32 v92, v14, s52, v92
    v_lshlrev_b32 v16, 16, v25
    v_and_b32 v17, 0xffff0000, v25
    v_mul_f32 v16, 0.15915494, v16
    v_mul_f32 v17, 0.15915494, v17
    v_fract_f32 v16, v16
    v_fract_f32 v17, v17
    v_cos_f32 v16, v16
    v_cos_f32 v17, v17
    s_nop 0
    v_cvt_pk_bf16_f32 v16, v16, v17
    v_lshl_or_b32 v90, v16, 16, v90
    v_and_or_b32 v94, v16, s52, v94
    s_mov_b32 s48, 90112
    buffer_load_dwordx2 v[24:25], v2, s[12:15], s48 offen nt
    s_waitcnt lgkmcnt(4)
    v_bitop3_b32 v89, v4, v6, v89 bitop3:0xca
    v_bitop3_b32 v93, v4, v7, v93 bitop3:0xca
    v_bitop3_b32 v91, v4, v8, v91 bitop3:0xca
    v_bitop3_b32 v95, v4, v9, v95 bitop3:0xca
    v_cmpx_gt_u32 vcc, s50, v6
    ds_write_b64 v6, v[88:89] offset:20736
    s_mov_b64 exec, -1
    v_cmpx_gt_u32 vcc, s50, v7
    ds_write_b64 v7, v[92:93] offset:20736
    s_mov_b64 exec, -1
    v_cmpx_gt_u32 vcc, s50, v8
    ds_write_b64 v8, v[90:91] offset:20736
    s_mov_b64 exec, -1
    v_cmpx_gt_u32 vcc, s50, v9
    ds_write_b64 v9, v[94:95] offset:20736
    s_mov_b64 exec, -1
    v_and_b32 v6, v4, v41
    ds_add_rtn_u32 v6, v6, v1
    v_and_b32 v7, v4, v45
    ds_add_rtn_u32 v7, v7, v1
    v_and_b32 v8, v4, v43
    ds_add_rtn_u32 v8, v8, v1
    v_and_b32 v9, v4, v47
    ds_add_rtn_u32 v9, v9, v1
    s_waitcnt lgkmcnt(4)
    v_bitop3_b32 v33, v4, v10, v33 bitop3:0xca
    v_bitop3_b32 v37, v4, v11, v37 bitop3:0xca
    v_bitop3_b32 v35, v4, v12, v35 bitop3:0xca
    v_bitop3_b32 v39, v4, v13, v39 bitop3:0xca
    v_cmpx_gt_u32 vcc, s50, v10
    ds_write_b64 v10, v[32:33] offset:20736
    s_mov_b64 exec, -1
    v_cmpx_gt_u32 vcc, s50, v11
    ds_write_b64 v11, v[36:37] offset:20736
    s_mov_b64 exec, -1
    v_cmpx_gt_u32 vcc, s50, v12
    ds_write_b64 v12, v[34:35] offset:20736
    s_mov_b64 exec, -1
    v_cmpx_gt_u32 vcc, s50, v13
    ds_write_b64 v13, v[38:39] offset:20736
    s_mov_b64 exec, -1
    v_and_b32 v10, v4, v49
    ds_add_rtn_u32 v10, v10, v1
    v_and_b32 v11, v4, v53
    ds_add_rtn_u32 v11, v11, v1
    v_and_b32 v12, v4, v51
    ds_add_rtn_u32 v12, v12, v1
    v_and_b32 v13, v4, v55
    ds_add_rtn_u32 v13, v13, v1
    s_waitcnt lgkmcnt(4)
    v_bitop3_b32 v41, v4, v6, v41 bitop3:0xca
    v_bitop3_b32 v45, v4, v7, v45 bitop3:0xca
    v_bitop3_b32 v43, v4, v8, v43 bitop3:0xca
    v_bitop3_b32 v47, v4, v9, v47 bitop3:0xca
    v_cmpx_gt_u32 vcc, s50, v6
    ds_write_b64 v6, v[40:41] offset:20736
    s_mov_b64 exec, -1
    v_cmpx_gt_u32 vcc, s50, v7
    ds_write_b64 v7, v[44:45] offset:20736
    s_mov_b64 exec, -1
    v_cmpx_gt_u32 vcc, s50, v8
    ds_write_b64 v8, v[42:43] offset:20736
    s_mov_b64 exec, -1
    v_cmpx_gt_u32 vcc, s50, v9
    ds_write_b64 v9, v[46:47] offset:20736
    s_mov_b64 exec, -1
    v_and_b32 v6, v4, v57
    ds_add_rtn_u32 v6, v6, v1
    v_and_b32 v7, v4, v61
    ds_add_rtn_u32 v7, v7, v1
    v_and_b32 v8, v4, v59
    ds_add_rtn_u32 v8, v8, v1
    v_and_b32 v9, v4, v63
    ds_add_rtn_u32 v9, v9, v1
    s_waitcnt lgkmcnt(4)
    v_bitop3_b32 v49, v4, v10, v49 bitop3:0xca
    v_bitop3_b32 v53, v4, v11, v53 bitop3:0xca
    v_bitop3_b32 v51, v4, v12, v51 bitop3:0xca
    v_bitop3_b32 v55, v4, v13, v55 bitop3:0xca
    v_cmpx_gt_u32 vcc, s50, v10
    ds_write_b64 v10, v[48:49] offset:20736
    s_mov_b64 exec, -1
    v_cmpx_gt_u32 vcc, s50, v11
    ds_write_b64 v11, v[52:53] offset:20736
    s_mov_b64 exec, -1
    v_cmpx_gt_u32 vcc, s50, v12
    ds_write_b64 v12, v[50:51] offset:20736
    s_mov_b64 exec, -1
    v_cmpx_gt_u32 vcc, s50, v13
    ds_write_b64 v13, v[54:55] offset:20736
    s_mov_b64 exec, -1
    v_and_b32 v10, v4, v97
    ds_add_rtn_u32 v10, v10, v1
    v_and_b32 v11, v4, v101
    ds_add_rtn_u32 v11, v11, v1
    v_and_b32 v12, v4, v99
    ds_add_rtn_u32 v12, v12, v1
    v_and_b32 v13, v4, v103
    ds_add_rtn_u32 v13, v13, v1
    s_waitcnt lgkmcnt(4)
    v_bitop3_b32 v57, v4, v6, v57 bitop3:0xca
    v_bitop3_b32 v61, v4, v7, v61 bitop3:0xca
    v_bitop3_b32 v59, v4, v8, v59 bitop3:0xca
    v_bitop3_b32 v63, v4, v9, v63 bitop3:0xca
    v_cmpx_gt_u32 vcc, s50, v6
    ds_write_b64 v6, v[56:57] offset:20736
    s_mov_b64 exec, -1
    v_cmpx_gt_u32 vcc, s50, v7
    ds_write_b64 v7, v[60:61] offset:20736
    s_mov_b64 exec, -1
    v_cmpx_gt_u32 vcc, s50, v8
    ds_write_b64 v8, v[58:59] offset:20736
    s_mov_b64 exec, -1
    v_cmpx_gt_u32 vcc, s50, v9
    ds_write_b64 v9, v[62:63] offset:20736
    s_mov_b64 exec, -1
    v_and_b32 v6, v4, v105
    ds_add_rtn_u32 v6, v6, v1
    v_and_b32 v7, v4, v109
    ds_add_rtn_u32 v7, v7, v1
    v_and_b32 v8, v4, v107
    ds_add_rtn_u32 v8, v8, v1
    v_and_b32 v9, v4, v111
    ds_add_rtn_u32 v9, v9, v1
    s_waitcnt vmcnt(3)
    v_lshlrev_b32 v14, 16, v18
    v_and_b32 v15, 0xffff0000, v18
    v_mul_f32 v14, 0.15915494, v14
    v_mul_f32 v15, 0.15915494, v15
    v_fract_f32 v14, v14
    v_fract_f32 v15, v15
    v_cos_f32 v14, v14
    v_cos_f32 v15, v15
    s_nop 0
    v_cvt_pk_bf16_f32 v14, v14, v15
    v_lshl_or_b32 v96, v14, 16, v96
    v_and_or_b32 v100, v14, s52, v100
    v_lshlrev_b32 v16, 16, v19
    v_and_b32 v17, 0xffff0000, v19
    v_mul_f32 v16, 0.15915494, v16
    v_mul_f32 v17, 0.15915494, v17
    v_fract_f32 v16, v16
    v_fract_f32 v17, v17
    v_cos_f32 v16, v16
    v_cos_f32 v17, v17
    s_nop 0
    v_cvt_pk_bf16_f32 v16, v16, v17
    v_lshl_or_b32 v98, v16, 16, v98
    v_and_or_b32 v102, v16, s52, v102
    s_waitcnt lgkmcnt(4)
    v_bitop3_b32 v97, v4, v10, v97 bitop3:0xca
    v_bitop3_b32 v101, v4, v11, v101 bitop3:0xca
    v_bitop3_b32 v99, v4, v12, v99 bitop3:0xca
    v_bitop3_b32 v103, v4, v13, v103 bitop3:0xca
    v_cmpx_gt_u32 vcc, s50, v10
    ds_write_b64 v10, v[96:97] offset:20736
    s_mov_b64 exec, -1
    v_cmpx_gt_u32 vcc, s50, v11
    ds_write_b64 v11, v[100:101] offset:20736
    s_mov_b64 exec, -1
    v_cmpx_gt_u32 vcc, s50, v12
    ds_write_b64 v12, v[98:99] offset:20736
    s_mov_b64 exec, -1
    v_cmpx_gt_u32 vcc, s50, v13
    ds_write_b64 v13, v[102:103] offset:20736
    s_mov_b64 exec, -1
    v_and_b32 v10, v4, v113
    ds_add_rtn_u32 v10, v10, v1
    v_and_b32 v11, v4, v117
    ds_add_rtn_u32 v11, v11, v1
    v_and_b32 v12, v4, v115
    ds_add_rtn_u32 v12, v12, v1
    v_and_b32 v13, v4, v119
    ds_add_rtn_u32 v13, v13, v1
    s_waitcnt vmcnt(2)
    v_lshlrev_b32 v14, 16, v20
    v_and_b32 v15, 0xffff0000, v20
    v_mul_f32 v14, 0.15915494, v14
    v_mul_f32 v15, 0.15915494, v15
    v_fract_f32 v14, v14
    v_fract_f32 v15, v15
    v_cos_f32 v14, v14
    v_cos_f32 v15, v15
    s_nop 0
    v_cvt_pk_bf16_f32 v14, v14, v15
    v_lshl_or_b32 v104, v14, 16, v104
    v_and_or_b32 v108, v14, s52, v108
    v_lshlrev_b32 v16, 16, v21
    v_and_b32 v17, 0xffff0000, v21
    v_mul_f32 v16, 0.15915494, v16
    v_mul_f32 v17, 0.15915494, v17
    v_fract_f32 v16, v16
    v_fract_f32 v17, v17
    v_cos_f32 v16, v16
    v_cos_f32 v17, v17
    s_nop 0
    v_cvt_pk_bf16_f32 v16, v16, v17
    v_lshl_or_b32 v106, v16, 16, v106
    v_and_or_b32 v110, v16, s52, v110
    s_waitcnt lgkmcnt(4)
    v_bitop3_b32 v105, v4, v6, v105 bitop3:0xca
    v_bitop3_b32 v109, v4, v7, v109 bitop3:0xca
    v_bitop3_b32 v107, v4, v8, v107 bitop3:0xca
    v_bitop3_b32 v111, v4, v9, v111 bitop3:0xca
    v_cmpx_gt_u32 vcc, s50, v6
    ds_write_b64 v6, v[104:105] offset:20736
    s_mov_b64 exec, -1
    v_cmpx_gt_u32 vcc, s50, v7
    ds_write_b64 v7, v[108:109] offset:20736
    s_mov_b64 exec, -1
    v_cmpx_gt_u32 vcc, s50, v8
    ds_write_b64 v8, v[106:107] offset:20736
    s_mov_b64 exec, -1
    v_cmpx_gt_u32 vcc, s50, v9
    ds_write_b64 v9, v[110:111] offset:20736
    s_mov_b64 exec, -1
    v_and_b32 v6, v4, v121
    ds_add_rtn_u32 v6, v6, v1
    v_and_b32 v7, v4, v125
    ds_add_rtn_u32 v7, v7, v1
    v_and_b32 v8, v4, v123
    ds_add_rtn_u32 v8, v8, v1
    v_and_b32 v9, v4, v127
    ds_add_rtn_u32 v9, v9, v1
    s_waitcnt vmcnt(1)
    v_lshlrev_b32 v14, 16, v22
    v_and_b32 v15, 0xffff0000, v22
    v_mul_f32 v14, 0.15915494, v14
    v_mul_f32 v15, 0.15915494, v15
    v_fract_f32 v14, v14
    v_fract_f32 v15, v15
    v_cos_f32 v14, v14
    v_cos_f32 v15, v15
    s_nop 0
    v_cvt_pk_bf16_f32 v14, v14, v15
    v_lshl_or_b32 v112, v14, 16, v112
    v_and_or_b32 v116, v14, s52, v116
    v_lshlrev_b32 v16, 16, v23
    v_and_b32 v17, 0xffff0000, v23
    v_mul_f32 v16, 0.15915494, v16
    v_mul_f32 v17, 0.15915494, v17
    v_fract_f32 v16, v16
    v_fract_f32 v17, v17
    v_cos_f32 v16, v16
    v_cos_f32 v17, v17
    s_nop 0
    v_cvt_pk_bf16_f32 v16, v16, v17
    v_lshl_or_b32 v114, v16, 16, v114
    v_and_or_b32 v118, v16, s52, v118
    s_waitcnt lgkmcnt(4)
    v_bitop3_b32 v113, v4, v10, v113 bitop3:0xca
    v_bitop3_b32 v117, v4, v11, v117 bitop3:0xca
    v_bitop3_b32 v115, v4, v12, v115 bitop3:0xca
    v_bitop3_b32 v119, v4, v13, v119 bitop3:0xca
    v_cmpx_gt_u32 vcc, s50, v10
    ds_write_b64 v10, v[112:113] offset:20736
    s_mov_b64 exec, -1
    v_cmpx_gt_u32 vcc, s50, v11
    ds_write_b64 v11, v[116:117] offset:20736
    s_mov_b64 exec, -1
    v_cmpx_gt_u32 vcc, s50, v12
    ds_write_b64 v12, v[114:115] offset:20736
    s_mov_b64 exec, -1
    v_cmpx_gt_u32 vcc, s50, v13
    ds_write_b64 v13, v[118:119] offset:20736
    s_mov_b64 exec, -1
    s_waitcnt vmcnt(0)
    v_lshlrev_b32 v14, 16, v24
    v_and_b32 v15, 0xffff0000, v24
    v_mul_f32 v14, 0.15915494, v14
    v_mul_f32 v15, 0.15915494, v15
    v_fract_f32 v14, v14
    v_fract_f32 v15, v15
    v_cos_f32 v14, v14
    v_cos_f32 v15, v15
    s_nop 0
    v_cvt_pk_bf16_f32 v14, v14, v15
    v_lshl_or_b32 v120, v14, 16, v120
    v_and_or_b32 v124, v14, s52, v124
    v_lshlrev_b32 v16, 16, v25
    v_and_b32 v17, 0xffff0000, v25
    v_mul_f32 v16, 0.15915494, v16
    v_mul_f32 v17, 0.15915494, v17
    v_fract_f32 v16, v16
    v_fract_f32 v17, v17
    v_cos_f32 v16, v16
    v_cos_f32 v17, v17
    s_nop 0
    v_cvt_pk_bf16_f32 v16, v16, v17
    v_lshl_or_b32 v122, v16, 16, v122
    v_and_or_b32 v126, v16, s52, v126
    s_waitcnt lgkmcnt(0)
    v_bitop3_b32 v121, v4, v6, v121 bitop3:0xca
    v_bitop3_b32 v125, v4, v7, v125 bitop3:0xca
    v_bitop3_b32 v123, v4, v8, v123 bitop3:0xca
    v_bitop3_b32 v127, v4, v9, v127 bitop3:0xca
    v_cmpx_gt_u32 vcc, s50, v6
    ds_write_b64 v6, v[120:121] offset:20736
    s_mov_b64 exec, -1
    v_cmpx_gt_u32 vcc, s50, v7
    ds_write_b64 v7, v[124:125] offset:20736
    s_mov_b64 exec, -1
    v_cmpx_gt_u32 vcc, s50, v8
    ds_write_b64 v8, v[122:123] offset:20736
    s_mov_b64 exec, -1
    v_cmpx_gt_u32 vcc, s50, v9
    ds_write_b64 v9, v[126:127] offset:20736
    s_mov_b64 exec, -1
k1_mj:
    v_mov_b32 v1, 143040
    v_mul_u32_u24 v2, 24, v0
    v_add_u32 v2, 20736, v2
    v_mov_b32 v4, 0xffc00000
    s_mov_b32 s51, 0
    s_mov_b32 s54, 5960
k1_co:
    s_min_u32 s50, s45, s54
    s_waitcnt lgkmcnt(0)
    s_barrier
    ds_read_b64 v[6:7], v2 offset:0
    ds_read_b64 v[8:9], v2 offset:8
    ds_read_b64 v[10:11], v2 offset:16
    ds_read_b64 v[12:13], v2 offset:24576
    ds_read_b64 v[14:15], v2 offset:24584
    ds_read_b64 v[16:17], v2 offset:24592
    ds_read_b64 v[18:19], v2 offset:49152
    ds_read_b64 v[20:21], v2 offset:49160
    ds_read_b64 v[22:23], v2 offset:49168
    v_add_u32 v5, 73728, v2
    s_waitcnt lgkmcnt(6)
    v_lshrrev_b32 v11, 10, v11
    v_bitop3_b32 v11, v4, v9, v11 bitop3:0xca
    v_mov_b32 v9, v10
    v_lshrrev_b32 v11, 10, v11
    v_bitop3_b32 v7, v4, v7, v11 bitop3:0xca
    s_sub_i32 s47, s50, 0
    s_add_u32 s48, s51, 0
    v_cmpx_gt_i32 vcc, s47, v0
    buffer_store_dwordx4 v[6:9], v3, s[16:19], s48 offen
    s_mov_b64 exec, -1
    s_waitcnt lgkmcnt(3)
    v_lshrrev_b32 v17, 10, v17
    v_bitop3_b32 v17, v4, v15, v17 bitop3:0xca
    v_mov_b32 v15, v16
    v_lshrrev_b32 v17, 10, v17
    v_bitop3_b32 v13, v4, v13, v17 bitop3:0xca
    s_sub_i32 s47, s50, 1024
    s_add_u32 s48, s51, 16384
    v_cmpx_gt_i32 vcc, s47, v0
    buffer_store_dwordx4 v[12:15], v3, s[16:19], s48 offen
    s_mov_b64 exec, -1
    s_waitcnt lgkmcnt(0)
    v_lshrrev_b32 v23, 10, v23
    v_bitop3_b32 v23, v4, v21, v23 bitop3:0xca
    v_mov_b32 v21, v22
    v_lshrrev_b32 v23, 10, v23
    v_bitop3_b32 v19, v4, v19, v23 bitop3:0xca
    s_sub_i32 s47, s50, 2048
    s_add_u32 s48, s51, 32768
    v_cmpx_gt_i32 vcc, s47, v0
    buffer_store_dwordx4 v[18:21], v3, s[16:19], s48 offen
    s_mov_b64 exec, -1
    ds_read_b64 v[6:7], v5 offset:0
    ds_read_b64 v[8:9], v5 offset:8
    ds_read_b64 v[10:11], v5 offset:16
    ds_read_b64 v[12:13], v5 offset:24576
    ds_read_b64 v[14:15], v5 offset:24584
    ds_read_b64 v[16:17], v5 offset:24592
    v_min_u32 v5, 114664, v5
    ds_read_b64 v[18:19], v5 offset:49152
    ds_read_b64 v[20:21], v5 offset:49160
    ds_read_b64 v[22:23], v5 offset:49168
    v_add_u32 v5, 147456, v2
    v_min_u32 v5, 163816, v5
    s_waitcnt lgkmcnt(6)
    v_lshrrev_b32 v11, 10, v11
    v_bitop3_b32 v11, v4, v9, v11 bitop3:0xca
    v_mov_b32 v9, v10
    v_lshrrev_b32 v11, 10, v11
    v_bitop3_b32 v7, v4, v7, v11 bitop3:0xca
    ds_read_b64 v[24:25], v5 offset:0
    ds_read_b64 v[26:27], v5 offset:8
    ds_read_b64 v[10:11], v5 offset:16
    s_waitcnt lgkmcnt(6)
    v_lshrrev_b32 v17, 10, v17
    v_bitop3_b32 v17, v4, v15, v17 bitop3:0xca
    v_mov_b32 v15, v16
    v_lshrrev_b32 v17, 10, v17
    v_bitop3_b32 v13, v4, v13, v17 bitop3:0xca
    s_waitcnt lgkmcnt(3)
    v_lshrrev_b32 v23, 10, v23
    v_bitop3_b32 v23, v4, v21, v23 bitop3:0xca
    v_mov_b32 v21, v22
    v_lshrrev_b32 v23, 10, v23
    v_bitop3_b32 v19, v4, v19, v23 bitop3:0xca
    s_waitcnt lgkmcnt(0)
    v_lshrrev_b32 v11, 10, v11
    v_bitop3_b32 v11, v4, v27, v11 bitop3:0xca
    v_mov_b32 v27, v10
    v_lshrrev_b32 v11, 10, v11
    v_bitop3_b32 v25, v4, v25, v11 bitop3:0xca
    s_sub_u32 s45, s45, s50
    s_cmp_eq_u32 s45, 0
    s_cbranch_scc1 k1_fin
    s_barrier
    v_sub_u32 v10, v33, v1
    v_and_b32 v10, 0x3fffff, v10
    v_cmpx_gt_u32 vcc, s49, v10
    ds_write_b64 v10, v[32:33]
    s_mov_b64 exec, -1
    v_sub_u32 v11, v37, v1
    v_and_b32 v11, 0x3fffff, v11
    v_cmpx_gt_u32 vcc, s49, v11
    ds_write_b64 v11, v[36:37]
    s_mov_b64 exec, -1
    v_sub_u32 v16, v35, v1
    v_and_b32 v16, 0x3fffff, v16
    v_cmpx_gt_u32 vcc, s49, v16
    ds_write_b64 v16, v[34:35]
    s_mov_b64 exec, -1
    v_sub_u32 v17, v39, v1
    v_and_b32 v17, 0x3fffff, v17
    v_cmpx_gt_u32 vcc, s49, v17
    ds_write_b64 v17, v[38:39]
    s_mov_b64 exec, -1
    v_sub_u32 v10, v41, v1
    v_and_b32 v10, 0x3fffff, v10
    v_cmpx_gt_u32 vcc, s49, v10
    ds_write_b64 v10, v[40:41]
    s_mov_b64 exec, -1
    s_sub_i32 s47, s50, 3072
    s_add_u32 s48, s51, 49152
    v_cmpx_gt_i32 vcc, s47, v0
    buffer_store_dwordx4 v[6:9], v3, s[16:19], s48 offen
    s_mov_b64 exec, -1
    v_sub_u32 v11, v45, v1
    v_and_b32 v11, 0x3fffff, v11
    v_cmpx_gt_u32 vcc, s49, v11
    ds_write_b64 v11, v[44:45]
    s_mov_b64 exec, -1
    v_sub_u32 v16, v43, v1
    v_and_b32 v16, 0x3fffff, v16
    v_cmpx_gt_u32 vcc, s49, v16
    ds_write_b64 v16, v[42:43]
    s_mov_b64 exec, -1
    v_sub_u32 v17, v47, v1
    v_and_b32 v17, 0x3fffff, v17
    v_cmpx_gt_u32 vcc, s49, v17
    ds_write_b64 v17, v[46:47]
    s_mov_b64 exec, -1
    v_sub_u32 v10, v49, v1
    v_and_b32 v10, 0x3fffff, v10
    v_cmpx_gt_u32 vcc, s49, v10
    ds_write_b64 v10, v[48:49]
    s_mov_b64 exec, -1
    v_sub_u32 v11, v53, v1
    v_and_b32 v11, 0x3fffff, v11
    v_cmpx_gt_u32 vcc, s49, v11
    ds_write_b64 v11, v[52:53]
    s_mov_b64 exec, -1
    v_sub_u32 v16, v51, v1
    v_and_b32 v16, 0x3fffff, v16
    v_cmpx_gt_u32 vcc, s49, v16
    ds_write_b64 v16, v[50:51]
    s_mov_b64 exec, -1
    v_sub_u32 v17, v55, v1
    v_and_b32 v17, 0x3fffff, v17
    v_cmpx_gt_u32 vcc, s49, v17
    ds_write_b64 v17, v[54:55]
    s_mov_b64 exec, -1
    v_sub_u32 v10, v57, v1
    v_and_b32 v10, 0x3fffff, v10
    v_cmpx_gt_u32 vcc, s49, v10
    ds_write_b64 v10, v[56:57]
    s_mov_b64 exec, -1
    v_sub_u32 v11, v61, v1
    v_and_b32 v11, 0x3fffff, v11
    v_cmpx_gt_u32 vcc, s49, v11
    ds_write_b64 v11, v[60:61]
    s_mov_b64 exec, -1
    v_sub_u32 v16, v59, v1
    v_and_b32 v16, 0x3fffff, v16
    v_cmpx_gt_u32 vcc, s49, v16
    ds_write_b64 v16, v[58:59]
    s_mov_b64 exec, -1
    s_sub_i32 s47, s50, 4096
    s_add_u32 s48, s51, 65536
    v_cmpx_gt_i32 vcc, s47, v0
    buffer_store_dwordx4 v[12:15], v3, s[16:19], s48 offen
    s_mov_b64 exec, -1
    v_sub_u32 v17, v63, v1
    v_and_b32 v17, 0x3fffff, v17
    v_cmpx_gt_u32 vcc, s49, v17
    ds_write_b64 v17, v[62:63]
    s_mov_b64 exec, -1
    v_sub_u32 v10, v65, v1
    v_and_b32 v10, 0x3fffff, v10
    v_cmpx_gt_u32 vcc, s49, v10
    ds_write_b64 v10, v[64:65]
    s_mov_b64 exec, -1
    v_sub_u32 v11, v69, v1
    v_and_b32 v11, 0x3fffff, v11
    v_cmpx_gt_u32 vcc, s49, v11
    ds_write_b64 v11, v[68:69]
    s_mov_b64 exec, -1
    v_sub_u32 v16, v67, v1
    v_and_b32 v16, 0x3fffff, v16
    v_cmpx_gt_u32 vcc, s49, v16
    ds_write_b64 v16, v[66:67]
    s_mov_b64 exec, -1
    v_sub_u32 v17, v71, v1
    v_and_b32 v17, 0x3fffff, v17
    v_cmpx_gt_u32 vcc, s49, v17
    ds_write_b64 v17, v[70:71]
    s_mov_b64 exec, -1
    v_sub_u32 v10, v73, v1
    v_and_b32 v10, 0x3fffff, v10
    v_cmpx_gt_u32 vcc, s49, v10
    ds_write_b64 v10, v[72:73]
    s_mov_b64 exec, -1
    v_sub_u32 v11, v77, v1
    v_and_b32 v11, 0x3fffff, v11
    v_cmpx_gt_u32 vcc, s49, v11
    ds_write_b64 v11, v[76:77]
    s_mov_b64 exec, -1
    v_sub_u32 v16, v75, v1
    v_and_b32 v16, 0x3fffff, v16
    v_cmpx_gt_u32 vcc, s49, v16
    ds_write_b64 v16, v[74:75]
    s_mov_b64 exec, -1
    v_sub_u32 v17, v79, v1
    v_and_b32 v17, 0x3fffff, v17
    v_cmpx_gt_u32 vcc, s49, v17
    ds_write_b64 v17, v[78:79]
    s_mov_b64 exec, -1
    v_sub_u32 v10, v81, v1
    v_and_b32 v10, 0x3fffff, v10
    v_cmpx_gt_u32 vcc, s49, v10
    ds_write_b64 v10, v[80:81]
    s_mov_b64 exec, -1
    s_sub_i32 s47, s50, 5120
    s_add_u32 s48, s51, 81920
    v_cmpx_gt_i32 vcc, s47, v0
    buffer_store_dwordx4 v[18:21], v3, s[16:19], s48 offen
    s_mov_b64 exec, -1
    v_sub_u32 v11, v85, v1
    v_and_b32 v11, 0x3fffff, v11
    v_cmpx_gt_u32 vcc, s49, v11
    ds_write_b64 v11, v[84:85]
    s_mov_b64 exec, -1
    v_sub_u32 v16, v83, v1
    v_and_b32 v16, 0x3fffff, v16
    v_cmpx_gt_u32 vcc, s49, v16
    ds_write_b64 v16, v[82:83]
    s_mov_b64 exec, -1
    v_sub_u32 v17, v87, v1
    v_and_b32 v17, 0x3fffff, v17
    v_cmpx_gt_u32 vcc, s49, v17
    ds_write_b64 v17, v[86:87]
    s_mov_b64 exec, -1
    v_sub_u32 v10, v89, v1
    v_and_b32 v10, 0x3fffff, v10
    v_cmpx_gt_u32 vcc, s49, v10
    ds_write_b64 v10, v[88:89]
    s_mov_b64 exec, -1
    v_sub_u32 v11, v93, v1
    v_and_b32 v11, 0x3fffff, v11
    v_cmpx_gt_u32 vcc, s49, v11
    ds_write_b64 v11, v[92:93]
    s_mov_b64 exec, -1
    v_sub_u32 v16, v91, v1
    v_and_b32 v16, 0x3fffff, v16
    v_cmpx_gt_u32 vcc, s49, v16
    ds_write_b64 v16, v[90:91]
    s_mov_b64 exec, -1
    v_sub_u32 v17, v95, v1
    v_and_b32 v17, 0x3fffff, v17
    v_cmpx_gt_u32 vcc, s49, v17
    ds_write_b64 v17, v[94:95]
    s_mov_b64 exec, -1
    v_sub_u32 v10, v97, v1
    v_and_b32 v10, 0x3fffff, v10
    v_cmpx_gt_u32 vcc, s49, v10
    ds_write_b64 v10, v[96:97]
    s_mov_b64 exec, -1
    v_sub_u32 v11, v101, v1
    v_and_b32 v11, 0x3fffff, v11
    v_cmpx_gt_u32 vcc, s49, v11
    ds_write_b64 v11, v[100:101]
    s_mov_b64 exec, -1
    v_sub_u32 v16, v99, v1
    v_and_b32 v16, 0x3fffff, v16
    v_cmpx_gt_u32 vcc, s49, v16
    ds_write_b64 v16, v[98:99]
    s_mov_b64 exec, -1
    s_sub_i32 s47, s50, 6144
    s_add_u32 s48, s51, 98304
    v_cmpx_gt_i32 vcc, s47, v0
    buffer_store_dwordx4 v[24:27], v3, s[16:19], s48 offen
    s_mov_b64 exec, -1
    v_sub_u32 v17, v103, v1
    v_and_b32 v17, 0x3fffff, v17
    v_cmpx_gt_u32 vcc, s49, v17
    ds_write_b64 v17, v[102:103]
    s_mov_b64 exec, -1
    v_sub_u32 v10, v105, v1
    v_and_b32 v10, 0x3fffff, v10
    v_cmpx_gt_u32 vcc, s49, v10
    ds_write_b64 v10, v[104:105]
    s_mov_b64 exec, -1
    v_sub_u32 v11, v109, v1
    v_and_b32 v11, 0x3fffff, v11
    v_cmpx_gt_u32 vcc, s49, v11
    ds_write_b64 v11, v[108:109]
    s_mov_b64 exec, -1
    v_sub_u32 v16, v107, v1
    v_and_b32 v16, 0x3fffff, v16
    v_cmpx_gt_u32 vcc, s49, v16
    ds_write_b64 v16, v[106:107]
    s_mov_b64 exec, -1
    v_sub_u32 v17, v111, v1
    v_and_b32 v17, 0x3fffff, v17
    v_cmpx_gt_u32 vcc, s49, v17
    ds_write_b64 v17, v[110:111]
    s_mov_b64 exec, -1
    v_sub_u32 v10, v113, v1
    v_and_b32 v10, 0x3fffff, v10
    v_cmpx_gt_u32 vcc, s49, v10
    ds_write_b64 v10, v[112:113]
    s_mov_b64 exec, -1
    v_sub_u32 v11, v117, v1
    v_and_b32 v11, 0x3fffff, v11
    v_cmpx_gt_u32 vcc, s49, v11
    ds_write_b64 v11, v[116:117]
    s_mov_b64 exec, -1
    v_sub_u32 v16, v115, v1
    v_and_b32 v16, 0x3fffff, v16
    v_cmpx_gt_u32 vcc, s49, v16
    ds_write_b64 v16, v[114:115]
    s_mov_b64 exec, -1
    v_sub_u32 v17, v119, v1
    v_and_b32 v17, 0x3fffff, v17
    v_cmpx_gt_u32 vcc, s49, v17
    ds_write_b64 v17, v[118:119]
    s_mov_b64 exec, -1
    v_sub_u32 v10, v121, v1
    v_and_b32 v10, 0x3fffff, v10
    v_cmpx_gt_u32 vcc, s49, v10
    ds_write_b64 v10, v[120:121]
    s_mov_b64 exec, -1
    v_sub_u32 v11, v125, v1
    v_and_b32 v11, 0x3fffff, v11
    v_cmpx_gt_u32 vcc, s49, v11
    ds_write_b64 v11, v[124:125]
    s_mov_b64 exec, -1
    v_sub_u32 v16, v123, v1
    v_and_b32 v16, 0x3fffff, v16
    v_cmpx_gt_u32 vcc, s49, v16
    ds_write_b64 v16, v[122:123]
    s_mov_b64 exec, -1
    v_sub_u32 v17, v127, v1
    v_and_b32 v17, 0x3fffff, v17
    v_cmpx_gt_u32 vcc, s49, v17
    ds_write_b64 v17, v[126:127]
    s_mov_b64 exec, -1
    v_sub_u32 v10, v31, v1
    v_and_b32 v10, 0x3fffff, v10
    v_cmpx_gt_u32 vcc, s49, v10
    ds_write_b64 v10, v[30:31]
    s_mov_b64 exec, -1
    v_add_u32 v1, 163776, v1
    v_mul_u32_u24 v2, 24, v0
    s_lshl_b32 s47, s50, 4
    s_add_u32 s51, s51, s47
    s_mov_b32 s54, 6824
    s_branch k1_co
k1_fin:
    s_sub_i32 s47, s50, 3072
    s_add_u32 s48, s51, 49152
    v_cmpx_gt_i32 vcc, s47, v0
    buffer_store_dwordx4 v[6:9], v3, s[16:19], s48 offen
    s_mov_b64 exec, -1
    s_sub_i32 s47, s50, 4096
    s_add_u32 s48, s51, 65536
    v_cmpx_gt_i32 vcc, s47, v0
    buffer_store_dwordx4 v[12:15], v3, s[16:19], s48 offen
    s_mov_b64 exec, -1
    s_sub_i32 s47, s50, 5120
    s_add_u32 s48, s51, 81920
    v_cmpx_gt_i32 vcc, s47, v0
    buffer_store_dwordx4 v[18:21], v3, s[16:19], s48 offen
    s_mov_b64 exec, -1
    s_sub_i32 s47, s50, 6144
    s_add_u32 s48, s51, 98304
    v_cmpx_gt_i32 vcc, s47, v0
    buffer_store_dwordx4 v[24:27], v3, s[16:19], s48 offen
    s_mov_b64 exec, -1
k1_done:
    s_endpgm
k1_gen:
    v_and_b32 v6, v4, v31
    v_cndmask_b32 v6, v4, v6, s[62:63]
    s_mov_b64 exec, s[62:63]
    ds_add_rtn_u32 v6, v6, v1
    s_mov_b64 exec, -1
    v_and_b32 v10, v4, v65
    ds_add_rtn_u32 v10, v10, v1
    v_and_b32 v11, v4, v69
    ds_add_rtn_u32 v11, v11, v1
    v_and_b32 v12, v4, v67
    ds_add_rtn_u32 v12, v12, v1
    v_and_b32 v13, v4, v71
    ds_add_rtn_u32 v13, v13, v1
    s_waitcnt vmcnt(8)
    v_lshlrev_b32 v14, 16, v27
    v_and_b32 v15, 0xffff0000, v27
    v_mul_f32 v14, v5, v14
    v_mul_f32 v15, v5, v15
    v_cvt_pk_bf16_f32 v15, v14, v15
    v_lshlrev_b32 v14, 16, v15
    v_and_b32 v15, 0xffff0000, v15
    v_mul_f32 v14, 0.15915494, v14
    v_mul_f32 v15, 0.15915494, v15
    v_fract_f32 v14, v14
    v_fract_f32 v15, v15
    v_cos_f32 v14, v14
    v_cos_f32 v15, v15
    s_nop 0
    v_cvt_pk_bf16_f32 v14, v14, v15
    v_lshl_or_b32 v30, v14, 16, v30
    v_and_or_b32 v29, v14, s52, v29
    s_waitcnt lgkmcnt(4)
    v_bitop3_b32 v31, v4, v6, v31 bitop3:0xca
    v_cmpx_gt_u32 vcc, s50, v6
    ds_write_b64 v6, v[30:31] offset:20736
    s_mov_b64 exec, -1
    v_and_b32 v6, v4, v73
    ds_add_rtn_u32 v6, v6, v1
    v_and_b32 v7, v4, v77
    ds_add_rtn_u32 v7, v7, v1
    v_and_b32 v8, v4, v75
    ds_add_rtn_u32 v8, v8, v1
    v_and_b32 v9, v4, v79
    ds_add_rtn_u32 v9, v9, v1
    s_waitcnt vmcnt(7)
    v_lshlrev_b32 v14, 16, v18
    v_and_b32 v15, 0xffff0000, v18
    v_mul_f32 v14, v5, v14
    v_mul_f32 v15, v5, v15
    v_cvt_pk_bf16_f32 v15, v14, v15
    v_lshlrev_b32 v14, 16, v15
    v_and_b32 v15, 0xffff0000, v15
    v_mul_f32 v14, 0.15915494, v14
    v_mul_f32 v15, 0.15915494, v15
    v_fract_f32 v14, v14
    v_fract_f32 v15, v15
    v_cos_f32 v14, v14
    v_cos_f32 v15, v15
    s_nop 0
    v_cvt_pk_bf16_f32 v14, v14, v15
    v_lshl_or_b32 v64, v14, 16, v64
    v_and_or_b32 v68, v14, s52, v68
    v_lshlrev_b32 v16, 16, v19
    v_and_b32 v17, 0xffff0000, v19
    v_mul_f32 v16, v5, v16
    v_mul_f32 v17, v5, v17
    v_cvt_pk_bf16_f32 v17, v16, v17
    v_lshlrev_b32 v16, 16, v17
    v_and_b32 v17, 0xffff0000, v17
    v_mul_f32 v16, 0.15915494, v16
    v_mul_f32 v17, 0.15915494, v17
    v_fract_f32 v16, v16
    v_fract_f32 v17, v17
    v_cos_f32 v16, v16
    v_cos_f32 v17, v17
    s_nop 0
    v_cvt_pk_bf16_f32 v16, v16, v17
    v_lshl_or_b32 v66, v16, 16, v66
    v_and_or_b32 v70, v16, s52, v70
    s_mov_b32 s48, 65536
    buffer_load_dwordx2 v[18:19], v2, s[12:15], s48 offen nt
    s_waitcnt lgkmcnt(4)
    v_bitop3_b32 v65, v4, v10, v65 bitop3:0xca
    v_bitop3_b32 v69, v4, v11, v69 bitop3:0xca
    v_bitop3_b32 v67, v4, v12, v67 bitop3:0xca
    v_bitop3_b32 v71, v4, v13, v71 bitop3:0xca
    v_cmpx_gt_u32 vcc, s50, v10
    ds_write_b64 v10, v[64:65] offset:20736
    s_mov_b64 exec, -1
    v_cmpx_gt_u32 vcc, s50, v11
    ds_write_b64 v11, v[68:69] offset:20736
    s_mov_b64 exec, -1
    v_cmpx_gt_u32 vcc, s50, v12
    ds_write_b64 v12, v[66:67] offset:20736
    s_mov_b64 exec, -1
    v_cmpx_gt_u32 vcc, s50, v13
    ds_write_b64 v13, v[70:71] offset:20736
    s_mov_b64 exec, -1
    v_and_b32 v10, v4, v81
    ds_add_rtn_u32 v10, v10, v1
    v_and_b32 v11, v4, v85
    ds_add_rtn_u32 v11, v11, v1
    v_and_b32 v12, v4, v83
    ds_add_rtn_u32 v12, v12, v1
    v_and_b32 v13, v4, v87
    ds_add_rtn_u32 v13, v13, v1
    s_waitcnt vmcnt(7)
    v_lshlrev_b32 v14, 16, v20
    v_and_b32 v15, 0xffff0000, v20
    v_mul_f32 v14, v5, v14
    v_mul_f32 v15, v5, v15
    v_cvt_pk_bf16_f32 v15, v14, v15
    v_lshlrev_b32 v14, 16, v15
    v_and_b32 v15, 0xffff0000, v15
    v_mul_f32 v14, 0.15915494, v14
    v_mul_f32 v15, 0.15915494, v15
    v_fract_f32 v14, v14
    v_fract_f32 v15, v15
    v_cos_f32 v14, v14
    v_cos_f32 v15, v15
    s_nop 0
    v_cvt_pk_bf16_f32 v14, v14, v15
    v_lshl_or_b32 v72, v14, 16, v72
    v_and_or_b32 v76, v14, s52, v76
    v_lshlrev_b32 v16, 16, v21
    v_and_b32 v17, 0xffff0000, v21
    v_mul_f32 v16, v5, v16
    v_mul_f32 v17, v5, v17
    v_cvt_pk_bf16_f32 v17, v16, v17
    v_lshlrev_b32 v16, 16, v17
    v_and_b32 v17, 0xffff0000, v17
    v_mul_f32 v16, 0.15915494, v16
    v_mul_f32 v17, 0.15915494, v17
    v_fract_f32 v16, v16
    v_fract_f32 v17, v17
    v_cos_f32 v16, v16
    v_cos_f32 v17, v17
    s_nop 0
    v_cvt_pk_bf16_f32 v16, v16, v17
    v_lshl_or_b32 v74, v16, 16, v74
    v_and_or_b32 v78, v16, s52, v78
    s_mov_b32 s48, 73728
    buffer_load_dwordx2 v[20:21], v2, s[12:15], s48 offen nt
    s_waitcnt lgkmcnt(4)
    v_bitop3_b32 v73, v4, v6, v73 bitop3:0xca
    v_bitop3_b32 v77, v4, v7, v77 bitop3:0xca
    v_bitop3_b32 v75, v4, v8, v75 bitop3:0xca
    v_bitop3_b32 v79, v4, v9, v79 bitop3:0xca
    v_cmpx_gt_u32 vcc, s50, v6
    ds_write_b64 v6, v[72:73] offset:20736
    s_mov_b64 exec, -1
    v_cmpx_gt_u32 vcc, s50, v7
    ds_write_b64 v7, v[76:77] offset:20736
    s_mov_b64 exec, -1
    v_cmpx_gt_u32 vcc, s50, v8
    ds_write_b64 v8, v[74:75] offset:20736
    s_mov_b64 exec, -1
    v_cmpx_gt_u32 vcc, s50, v9
    ds_write_b64 v9, v[78:79] offset:20736
    s_mov_b64 exec, -1
    v_and_b32 v6, v4, v89
    ds_add_rtn_u32 v6, v6, v1
    v_and_b32 v7, v4, v93
    ds_add_rtn_u32 v7, v7, v1
    v_and_b32 v8, v4, v91
    ds_add_rtn_u32 v8, v8, v1
    v_and_b32 v9, v4, v95
    ds_add_rtn_u32 v9, v9, v1
    s_waitcnt vmcnt(7)
    v_lshlrev_b32 v14, 16, v22
    v_and_b32 v15, 0xffff0000, v22
    v_mul_f32 v14, v5, v14
    v_mul_f32 v15, v5, v15
    v_cvt_pk_bf16_f32 v15, v14, v15
    v_lshlrev_b32 v14, 16, v15
    v_and_b32 v15, 0xffff0000, v15
    v_mul_f32 v14, 0.15915494, v14
    v_mul_f32 v15, 0.15915494, v15
    v_fract_f32 v14, v14
    v_fract_f32 v15, v15
    v_cos_f32 v14, v14
    v_cos_f32 v15, v15
    s_nop 0
    v_cvt_pk_bf16_f32 v14, v14, v15
    v_lshl_or_b32 v80, v14, 16, v80
    v_and_or_b32 v84, v14, s52, v84
    v_lshlrev_b32 v16, 16, v23
    v_and_b32 v17, 0xffff0000, v23
    v_mul_f32 v16, v5, v16
    v_mul_f32 v17, v5, v17
    v_cvt_pk_bf16_f32 v17, v16, v17
    v_lshlrev_b32 v16, 16, v17
    v_and_b32 v17, 0xffff0000, v17
    v_mul_f32 v16, 0.15915494, v16
    v_mul_f32 v17, 0.15915494, v17
    v_fract_f32 v16, v16
    v_fract_f32 v17, v17
    v_cos_f32 v16, v16
    v_cos_f32 v17, v17
    s_nop 0
    v_cvt_pk_bf16_f32 v16, v16, v17
    v_lshl_or_b32 v82, v16, 16, v82
    v_and_or_b32 v86, v16, s52, v86
    s_mov_b32 s48, 81920
    buffer_load_dwordx2 v[22:23], v2, s[12:15], s48 offen nt
    s_waitcnt lgkmcnt(4)
    v_bitop3_b32 v81, v4, v10, v81 bitop3:0xca
    v_bitop3_b32 v85, v4, v11, v85 bitop3:0xca
    v_bitop3_b32 v83, v4, v12, v83 bitop3:0xca
    v_bitop3_b32 v87, v4, v13, v87 bitop3:0xca
    v_cmpx_gt_u32 vcc, s50, v10
    ds_write_b64 v10, v[80:81] offset:20736
    s_mov_b64 exec, -1
    v_cmpx_gt_u32 vcc, s50, v11
    ds_write_b64 v11, v[84:85] offset:20736
    s_mov_b64 exec, -1
    v_cmpx_gt_u32 vcc, s50, v12
    ds_write_b64 v12, v[82:83] offset:20736
    s_mov_b64 exec, -1
    v_cmpx_gt_u32 vcc, s50, v13
    ds_write_b64 v13, v[86:87] offset:20736
    s_mov_b64 exec, -1
    v_and_b32 v10, v4, v33
    ds_add_rtn_u32 v10, v10, v1
    v_and_b32 v11, v4, v37
    ds_add_rtn_u32 v11, v11, v1
    v_and_b32 v12, v4, v35
    ds_add_rtn_u32 v12, v12, v1
    v_and_b32 v13, v4, v39
    ds_add_rtn_u32 v13, v13, v1
    s_waitcnt vmcnt(7)
    v_lshlrev_b32 v14, 16, v24
    v_and_b32 v15, 0xffff0000, v24
    v_mul_f32 v14, v5, v14
    v_mul_f32 v15, v5, v15
    v_cvt_pk_bf16_f32 v15, v14, v15
    v_lshlrev_b32 v14, 16, v15
    v_and_b32 v15, 0xffff0000, v15
    v_mul_f32 v14, 0.15915494, v14
    v_mul_f32 v15, 0.15915494, v15
    v_fract_f32 v14, v14
    v_fract_f32 v15, v15
    v_cos_f32 v14, v14
    v_cos_f32 v15, v15
    s_nop 0
    v_cvt_pk_bf16_f32 v14, v14, v15
    v_lshl_or_b32 v88, v14, 16, v88
    v_and_or_b32 v92, v14, s52, v92
    v_lshlrev_b32 v16, 16, v25
    v_and_b32 v17, 0xffff0000, v25
    v_mul_f32 v16, v5, v16
    v_mul_f32 v17, v5, v17
    v_cvt_pk_bf16_f32 v17, v16, v17
    v_lshlrev_b32 v16, 16, v17
    v_and_b32 v17, 0xffff0000, v17
    v_mul_f32 v16, 0.15915494, v16
    v_mul_f32 v17, 0.15915494, v17
    v_fract_f32 v16, v16
    v_fract_f32 v17, v17
    v_cos_f32 v16, v16
    v_cos_f32 v17, v17
    s_nop 0
    v_cvt_pk_bf16_f32 v16, v16, v17
    v_lshl_or_b32 v90, v16, 16, v90
    v_and_or_b32 v94, v16, s52, v94
    s_mov_b32 s48, 90112
    buffer_load_dwordx2 v[24:25], v2, s[12:15], s48 offen nt
    s_waitcnt lgkmcnt(4)
    v_bitop3_b32 v89, v4, v6, v89 bitop3:0xca
    v_bitop3_b32 v93, v4, v7, v93 bitop3:0xca
    v_bitop3_b32 v91, v4, v8, v91 bitop3:0xca
    v_bitop3_b32 v95, v4, v9, v95 bitop3:0xca
    v_cmpx_gt_u32 vcc, s50, v6
    ds_write_b64 v6, v[88:89] offset:20736
    s_mov_b64 exec, -1
    v_cmpx_gt_u32 vcc, s50, v7
    ds_write_b64 v7, v[92:93] offset:20736
    s_mov_b64 exec, -1
    v_cmpx_gt_u32 vcc, s50, v8
    ds_write_b64 v8, v[90:91] offset:20736
    s_mov_b64 exec, -1
    v_cmpx_gt_u32 vcc, s50, v9
    ds_write_b64 v9, v[94:95] offset:20736
    s_mov_b64 exec, -1
    v_and_b32 v6, v4, v41
    ds_add_rtn_u32 v6, v6, v1
    v_and_b32 v7, v4, v45
    ds_add_rtn_u32 v7, v7, v1
    v_and_b32 v8, v4, v43
    ds_add_rtn_u32 v8, v8, v1
    v_and_b32 v9, v4, v47
    ds_add_rtn_u32 v9, v9, v1
    s_waitcnt lgkmcnt(4)
    v_bitop3_b32 v33, v4, v10, v33 bitop3:0xca
    v_bitop3_b32 v37, v4, v11, v37 bitop3:0xca
    v_bitop3_b32 v35, v4, v12, v35 bitop3:0xca
    v_bitop3_b32 v39, v4, v13, v39 bitop3:0xca
    v_cmpx_gt_u32 vcc, s50, v10
    ds_write_b64 v10, v[32:33] offset:20736
    s_mov_b64 exec, -1
    v_cmpx_gt_u32 vcc, s50, v11
    ds_write_b64 v11, v[36:37] offset:20736
    s_mov_b64 exec, -1
    v_cmpx_gt_u32 vcc, s50, v12
    ds_write_b64 v12, v[34:35] offset:20736
    s_mov_b64 exec, -1
    v_cmpx_gt_u32 vcc, s50, v13
    ds_write_b64 v13, v[38:39] offset:20736
    s_mov_b64 exec, -1
    v_and_b32 v10, v4, v49
    ds_add_rtn_u32 v10, v10, v1
    v_and_b32 v11, v4, v53
    ds_add_rtn_u32 v11, v11, v1
    v_and_b32 v12, v4, v51
    ds_add_rtn_u32 v12, v12, v1
    v_and_b32 v13, v4, v55
    ds_add_rtn_u32 v13, v13, v1
    s_waitcnt lgkmcnt(4)
    v_bitop3_b32 v41, v4, v6, v41 bitop3:0xca
    v_bitop3_b32 v45, v4, v7, v45 bitop3:0xca
    v_bitop3_b32 v43, v4, v8, v43 bitop3:0xca
    v_bitop3_b32 v47, v4, v9, v47 bitop3:0xca
    v_cmpx_gt_u32 vcc, s50, v6
    ds_write_b64 v6, v[40:41] offset:20736
    s_mov_b64 exec, -1
    v_cmpx_gt_u32 vcc, s50, v7
    ds_write_b64 v7, v[44:45] offset:20736
    s_mov_b64 exec, -1
    v_cmpx_gt_u32 vcc, s50, v8
    ds_write_b64 v8, v[42:43] offset:20736
    s_mov_b64 exec, -1
    v_cmpx_gt_u32 vcc, s50, v9
    ds_write_b64 v9, v[46:47] offset:20736
    s_mov_b64 exec, -1
    v_and_b32 v6, v4, v57
    ds_add_rtn_u32 v6, v6, v1
    v_and_b32 v7, v4, v61
    ds_add_rtn_u32 v7, v7, v1
    v_and_b32 v8, v4, v59
    ds_add_rtn_u32 v8, v8, v1
    v_and_b32 v9, v4, v63
    ds_add_rtn_u32 v9, v9, v1
    s_waitcnt lgkmcnt(4)
    v_bitop3_b32 v49, v4, v10, v49 bitop3:0xca
    v_bitop3_b32 v53, v4, v11, v53 bitop3:0xca
    v_bitop3_b32 v51, v4, v12, v51 bitop3:0xca
    v_bitop3_b32 v55, v4, v13, v55 bitop3:0xca
    v_cmpx_gt_u32 vcc, s50, v10
    ds_write_b64 v10, v[48:49] offset:20736
    s_mov_b64 exec, -1
    v_cmpx_gt_u32 vcc, s50, v11
    ds_write_b64 v11, v[52:53] offset:20736
    s_mov_b64 exec, -1
    v_cmpx_gt_u32 vcc, s50, v12
    ds_write_b64 v12, v[50:51] offset:20736
    s_mov_b64 exec, -1
    v_cmpx_gt_u32 vcc, s50, v13
    ds_write_b64 v13, v[54:55] offset:20736
    s_mov_b64 exec, -1
    v_and_b32 v10, v4, v97
    ds_add_rtn_u32 v10, v10, v1
    v_and_b32 v11, v4, v101
    ds_add_rtn_u32 v11, v11, v1
    v_and_b32 v12, v4, v99
    ds_add_rtn_u32 v12, v12, v1
    v_and_b32 v13, v4, v103
    ds_add_rtn_u32 v13, v13, v1
    s_waitcnt lgkmcnt(4)
    v_bitop3_b32 v57, v4, v6, v57 bitop3:0xca
    v_bitop3_b32 v61, v4, v7, v61 bitop3:0xca
    v_bitop3_b32 v59, v4, v8, v59 bitop3:0xca
    v_bitop3_b32 v63, v4, v9, v63 bitop3:0xca
    v_cmpx_gt_u32 vcc, s50, v6
    ds_write_b64 v6, v[56:57] offset:20736
    s_mov_b64 exec, -1
    v_cmpx_gt_u32 vcc, s50, v7
    ds_write_b64 v7, v[60:61] offset:20736
    s_mov_b64 exec, -1
    v_cmpx_gt_u32 vcc, s50, v8
    ds_write_b64 v8, v[58:59] offset:20736
    s_mov_b64 exec, -1
    v_cmpx_gt_u32 vcc, s50, v9
    ds_write_b64 v9, v[62:63] offset:20736
    s_mov_b64 exec, -1
    v_and_b32 v6, v4, v105
    ds_add_rtn_u32 v6, v6, v1
    v_and_b32 v7, v4, v109
    ds_add_rtn_u32 v7, v7, v1
    v_and_b32 v8, v4, v107
    ds_add_rtn_u32 v8, v8, v1
    v_and_b32 v9, v4, v111
    ds_add_rtn_u32 v9, v9, v1
    s_waitcnt vmcnt(3)
    v_lshlrev_b32 v14, 16, v18
    v_and_b32 v15, 0xffff0000, v18
    v_mul_f32 v14, v5, v14
    v_mul_f32 v15, v5, v15
    v_cvt_pk_bf16_f32 v15, v14, v15
    v_lshlrev_b32 v14, 16, v15
    v_and_b32 v15, 0xffff0000, v15
    v_mul_f32 v14, 0.15915494, v14
    v_mul_f32 v15, 0.15915494, v15
    v_fract_f32 v14, v14
    v_fract_f32 v15, v15
    v_cos_f32 v14, v14
    v_cos_f32 v15, v15
    s_nop 0
    v_cvt_pk_bf16_f32 v14, v14, v15
    v_lshl_or_b32 v96, v14, 16, v96
    v_and_or_b32 v100, v14, s52, v100
    v_lshlrev_b32 v16, 16, v19
    v_and_b32 v17, 0xffff0000, v19
    v_mul_f32 v16, v5, v16
    v_mul_f32 v17, v5, v17
    v_cvt_pk_bf16_f32 v17, v16, v17
    v_lshlrev_b32 v16, 16, v17
    v_and_b32 v17, 0xffff0000, v17
    v_mul_f32 v16, 0.15915494, v16
    v_mul_f32 v17, 0.15915494, v17
    v_fract_f32 v16, v16
    v_fract_f32 v17, v17
    v_cos_f32 v16, v16
    v_cos_f32 v17, v17
    s_nop 0
    v_cvt_pk_bf16_f32 v16, v16, v17
    v_lshl_or_b32 v98, v16, 16, v98
    v_and_or_b32 v102, v16, s52, v102
    s_waitcnt lgkmcnt(4)
    v_bitop3_b32 v97, v4, v10, v97 bitop3:0xca
    v_bitop3_b32 v101, v4, v11, v101 bitop3:0xca
    v_bitop3_b32 v99, v4, v12, v99 bitop3:0xca
    v_bitop3_b32 v103, v4, v13, v103 bitop3:0xca
    v_cmpx_gt_u32 vcc, s50, v10
    ds_write_b64 v10, v[96:97] offset:20736
    s_mov_b64 exec, -1
    v_cmpx_gt_u32 vcc, s50, v11
    ds_write_b64 v11, v[100:101] offset:20736
    s_mov_b64 exec, -1
    v_cmpx_gt_u32 vcc, s50, v12
    ds_write_b64 v12, v[98:99] offset:20736
    s_mov_b64 exec, -1
    v_cmpx_gt_u32 vcc, s50, v13
    ds_write_b64 v13, v[102:103] offset:20736
    s_mov_b64 exec, -1
    v_and_b32 v10, v4, v113
    ds_add_rtn_u32 v10, v10, v1
    v_and_b32 v11, v4, v117
    ds_add_rtn_u32 v11, v11, v1
    v_and_b32 v12, v4, v115
    ds_add_rtn_u32 v12, v12, v1
    v_and_b32 v13, v4, v119
    ds_add_rtn_u32 v13, v13, v1
    s_waitcnt vmcnt(2)
    v_lshlrev_b32 v14, 16, v20
    v_and_b32 v15, 0xffff0000, v20
    v_mul_f32 v14, v5, v14
    v_mul_f32 v15, v5, v15
    v_cvt_pk_bf16_f32 v15, v14, v15
    v_lshlrev_b32 v14, 16, v15
    v_and_b32 v15, 0xffff0000, v15
    v_mul_f32 v14, 0.15915494, v14
    v_mul_f32 v15, 0.15915494, v15
    v_fract_f32 v14, v14
    v_fract_f32 v15, v15
    v_cos_f32 v14, v14
    v_cos_f32 v15, v15
    s_nop 0
    v_cvt_pk_bf16_f32 v14, v14, v15
    v_lshl_or_b32 v104, v14, 16, v104
    v_and_or_b32 v108, v14, s52, v108
    v_lshlrev_b32 v16, 16, v21
    v_and_b32 v17, 0xffff0000, v21
    v_mul_f32 v16, v5, v16
    v_mul_f32 v17, v5, v17
    v_cvt_pk_bf16_f32 v17, v16, v17
    v_lshlrev_b32 v16, 16, v17
    v_and_b32 v17, 0xffff0000, v17
    v_mul_f32 v16, 0.15915494, v16
    v_mul_f32 v17, 0.15915494, v17
    v_fract_f32 v16, v16
    v_fract_f32 v17, v17
    v_cos_f32 v16, v16
    v_cos_f32 v17, v17
    s_nop 0
    v_cvt_pk_bf16_f32 v16, v16, v17
    v_lshl_or_b32 v106, v16, 16, v106
    v_and_or_b32 v110, v16, s52, v110
    s_waitcnt lgkmcnt(4)
    v_bitop3_b32 v105, v4, v6, v105 bitop3:0xca
    v_bitop3_b32 v109, v4, v7, v109 bitop3:0xca
    v_bitop3_b32 v107, v4, v8, v107 bitop3:0xca
    v_bitop3_b32 v111, v4, v9, v111 bitop3:0xca
    v_cmpx_gt_u32 vcc, s50, v6
    ds_write_b64 v6, v[104:105] offset:20736
    s_mov_b64 exec, -1
    v_cmpx_gt_u32 vcc, s50, v7
    ds_write_b64 v7, v[108:109] offset:20736
    s_mov_b64 exec, -1
    v_cmpx_gt_u32 vcc, s50, v8
    ds_write_b64 v8, v[106:107] offset:20736
    s_mov_b64 exec, -1
    v_cmpx_gt_u32 vcc, s50, v9
    ds_write_b64 v9, v[110:111] offset:20736
    s_mov_b64 exec, -1
    v_and_b32 v6, v4, v121
    ds_add_rtn_u32 v6, v6, v1
    v_and_b32 v7, v4, v125
    ds_add_rtn_u32 v7, v7, v1
    v_and_b32 v8, v4, v123
    ds_add_rtn_u32 v8, v8, v1
    v_and_b32 v9, v4, v127
    ds_add_rtn_u32 v9, v9, v1
    s_waitcnt vmcnt(1)
    v_lshlrev_b32 v14, 16, v22
    v_and_b32 v15, 0xffff0000, v22
    v_mul_f32 v14, v5, v14
    v_mul_f32 v15, v5, v15
    v_cvt_pk_bf16_f32 v15, v14, v15
    v_lshlrev_b32 v14, 16, v15
    v_and_b32 v15, 0xffff0000, v15
    v_mul_f32 v14, 0.15915494, v14
    v_mul_f32 v15, 0.15915494, v15
    v_fract_f32 v14, v14
    v_fract_f32 v15, v15
    v_cos_f32 v14, v14
    v_cos_f32 v15, v15
    s_nop 0
    v_cvt_pk_bf16_f32 v14, v14, v15
    v_lshl_or_b32 v112, v14, 16, v112
    v_and_or_b32 v116, v14, s52, v116
    v_lshlrev_b32 v16, 16, v23
    v_and_b32 v17, 0xffff0000, v23
    v_mul_f32 v16, v5, v16
    v_mul_f32 v17, v5, v17
    v_cvt_pk_bf16_f32 v17, v16, v17
    v_lshlrev_b32 v16, 16, v17
    v_and_b32 v17, 0xffff0000, v17
    v_mul_f32 v16, 0.15915494, v16
    v_mul_f32 v17, 0.15915494, v17
    v_fract_f32 v16, v16
    v_fract_f32 v17, v17
    v_cos_f32 v16, v16
    v_cos_f32 v17, v17
    s_nop 0
    v_cvt_pk_bf16_f32 v16, v16, v17
    v_lshl_or_b32 v114, v16, 16, v114
    v_and_or_b32 v118, v16, s52, v118
    s_waitcnt lgkmcnt(4)
    v_bitop3_b32 v113, v4, v10, v113 bitop3:0xca
    v_bitop3_b32 v117, v4, v11, v117 bitop3:0xca
    v_bitop3_b32 v115, v4, v12, v115 bitop3:0xca
    v_bitop3_b32 v119, v4, v13, v119 bitop3:0xca
    v_cmpx_gt_u32 vcc, s50, v10
    ds_write_b64 v10, v[112:113] offset:20736
    s_mov_b64 exec, -1
    v_cmpx_gt_u32 vcc, s50, v11
    ds_write_b64 v11, v[116:117] offset:20736
    s_mov_b64 exec, -1
    v_cmpx_gt_u32 vcc, s50, v12
    ds_write_b64 v12, v[114:115] offset:20736
    s_mov_b64 exec, -1
    v_cmpx_gt_u32 vcc, s50, v13
    ds_write_b64 v13, v[118:119] offset:20736
    s_mov_b64 exec, -1
    s_waitcnt vmcnt(0)
    v_lshlrev_b32 v14, 16, v24
    v_and_b32 v15, 0xffff0000, v24
    v_mul_f32 v14, v5, v14
    v_mul_f32 v15, v5, v15
    v_cvt_pk_bf16_f32 v15, v14, v15
    v_lshlrev_b32 v14, 16, v15
    v_and_b32 v15, 0xffff0000, v15
    v_mul_f32 v14, 0.15915494, v14
    v_mul_f32 v15, 0.15915494, v15
    v_fract_f32 v14, v14
    v_fract_f32 v15, v15
    v_cos_f32 v14, v14
    v_cos_f32 v15, v15
    s_nop 0
    v_cvt_pk_bf16_f32 v14, v14, v15
    v_lshl_or_b32 v120, v14, 16, v120
    v_and_or_b32 v124, v14, s52, v124
    v_lshlrev_b32 v16, 16, v25
    v_and_b32 v17, 0xffff0000, v25
    v_mul_f32 v16, v5, v16
    v_mul_f32 v17, v5, v17
    v_cvt_pk_bf16_f32 v17, v16, v17
    v_lshlrev_b32 v16, 16, v17
    v_and_b32 v17, 0xffff0000, v17
    v_mul_f32 v16, 0.15915494, v16
    v_mul_f32 v17, 0.15915494, v17
    v_fract_f32 v16, v16
    v_fract_f32 v17, v17
    v_cos_f32 v16, v16
    v_cos_f32 v17, v17
    s_nop 0
    v_cvt_pk_bf16_f32 v16, v16, v17
    v_lshl_or_b32 v122, v16, 16, v122
    v_and_or_b32 v126, v16, s52, v126
    s_waitcnt lgkmcnt(0)
    v_bitop3_b32 v121, v4, v6, v121 bitop3:0xca
    v_bitop3_b32 v125, v4, v7, v125 bitop3:0xca
    v_bitop3_b32 v123, v4, v8, v123 bitop3:0xca
    v_bitop3_b32 v127, v4, v9, v127 bitop3:0xca
    v_cmpx_gt_u32 vcc, s50, v6
    ds_write_b64 v6, v[120:121] offset:20736
    s_mov_b64 exec, -1
    v_cmpx_gt_u32 vcc, s50, v7
    ds_write_b64 v7, v[124:125] offset:20736
    s_mov_b64 exec, -1
    v_cmpx_gt_u32 vcc, s50, v8
    ds_write_b64 v8, v[122:123] offset:20736
    s_mov_b64 exec, -1
    v_cmpx_gt_u32 vcc, s50, v9
    ds_write_b64 v9, v[126:127] offset:20736
    s_mov_b64 exec, -1
    s_branch k1_mj
.text
.globl k2_kernel
.p2align 8
.type k2_kernel,@function
k2_kernel:
    s_cmp_ge_u32 s2, 256
    s_cbranch_scc1 k2_done
    s_load_dwordx2 s[20:21], s[0:1], 0
    s_load_dwordx2 s[22:23], s[0:1], 104
    s_load_dwordx2 s[16:17], s[0:1], 24
    s_load_dwordx2 s[68:69], s[0:1], 40
    s_load_dwordx4 s[80:83], s[0:1], 56
    s_load_dwordx4 s[84:87], s[0:1], 72
    s_getpc_b64 s[48:49]
k2ct_pc:
    s_bfe_u32 s39, s2, 0x30003
    s_lshl_b32 s39, s39, 13
    v_and_b32 v46, 63, v0
    v_lshlrev_b32 v46, 7, v46
    v_add_u32 v46, s39, v46
    v_min_u32 v46, k2_code_end-k2ct_pc-4, v46
    v_mov_b32 v47, s49
    v_add_co_u32 v46, vcc, s48, v46
    v_cmp_gt_u32 s[48:49], 64, v0
    s_nop 0
    v_addc_co_u32 v47, vcc, 0, v47, vcc
    s_and_saveexec_b64 s[48:49], s[48:49]
    s_cbranch_execz k2ct_skip
    global_load_dword v46, v[46:47], off
k2ct_skip:
    s_mov_b64 exec, -1
    v_lshrrev_b32 v56, 6, v0
    v_and_b32 v57, 63, v0
    v_readfirstlane_b32 s32, v56
    v_lshlrev_b32 v3, 4, v0
    v_lshlrev_b32 v1, 4, v57
    s_and_b32 s39, s2, 7
    s_lshr_b32 s34, s39, 1
    s_lshr_b32 s33, s2, 3
    s_and_b32 s39, s2, 1
    s_lshl_b32 s39, s39, 5
    s_add_u32 s33, s33, s39
    s_lshl_b32 s45, s34, 6
    s_add_u32 s45, s45, s33
    v_lshrrev_b32 v4, 1, v3
    v_add_u32 v4, 32768, v4
    v_min_u32 v4, 40056, v4
    s_mul_i32 s36, s34, 801280
    s_mov_b32 s41, 0xffff0000
    s_mov_b32 s40, 321920
    v_mov_b32 v6, 0xffff0000
    s_cmp_lt_u32 s32, 4
    s_cbranch_scc1 k2_rl0
    v_add_u32 v60, -256, v0
    v_mul_u32_u24 v58, 0xaaab, v60
    v_lshrrev_b32 v58, 17, v58
    v_mul_u32_u24 v59, 3, v58
    v_sub_u32 v59, v60, v59
    s_branch k2_rl1
k2_rl0:
    v_mov_b32 v58, v0
    v_mov_b32 v59, 3
k2_rl1:
    v_mul_u32_u24 v56, 96, v58
    v_add_u32 v56, 40960, v56
    s_mul_i32 s39, s45, 80
    s_mov_b32 s41, 43691
    v_add_u32 v25, 1024, v0
    v_mul_u32_u24 v26, s41, v0
    v_mul_u32_u24 v27, s41, v25
    v_lshrrev_b32 v26, 18, v26
    v_lshrrev_b32 v27, 18, v27
    v_mul_u32_u24 v28, 20400, v26
    v_mul_u32_u24 v29, 20400, v27
    v_add3_u32 v24, v28, v3, s39
    v_add3_u32 v25, v29, v3, s39
    v_add_u32 v25, 16384, v25
    v_mov_b32 v26, 512
    v_cmp_lt_u32 s[52:53], v0, v26
    v_mul_lo_u32 v2, v58, s40
    v_lshl_add_u32 v2, v59, 4, v2
    v_mul_u32_u24 v104, 3, v59
    v_add_u32 v104, 1, v104
    v_lshlrev_b32 v104, 19, v104
    v_add_u32 v105, 0x80000, v104
    v_add_u32 v106, 0x100000, v104
    s_waitcnt lgkmcnt(0)
    s_add_u32 s4, s22, 0
    s_addc_u32 s5, s23, 0
    s_mov_b32 s6, 82411520
    s_mov_b32 s7, 0x00020000
    s_add_u32 s8, s22, 83886080
    s_addc_u32 s9, s23, 0
    s_mov_b32 s10, 5246976
    s_mov_b32 s11, 0x00020000
    s_add_u32 s12, s20, 0
    s_addc_u32 s13, s21, 0
    s_mov_b32 s14, 3200000
    s_mov_b32 s15, 0x00020000
    s_add_u32 s14, s36, 801280
    s_min_u32 s14, s14, 3200000
    s_mul_i32 s101, s32, 2560
    s_add_u32 s39, s101, s36
    v_lshrrev_b32 v4, 2, v1
    v_add_u32 v4, s39, v4
    s_add_u32 s24, s22, 89194496
    s_addc_u32 s25, s23, 0
    s_mov_b32 s26, 1024
    s_mov_b32 s27, 0x00020000
    buffer_load_dwordx4 v[34:37], v1, s[24:27], 0 offen
    s_lshl_b32 s39, s32, 10
    s_add_u32 m0, s39, 40960
    s_nop 0
    buffer_load_dwordx4 v24, s[8:11], 0 offen lds
    s_add_u32 m0, s39, 57344
    s_mov_b64 exec, s[52:53]
    buffer_load_dwordx4 v25, s[8:11], 0 offen lds
    s_mov_b64 exec, -1
    buffer_load_dword v14, v4, s[12:15], 0 offen offset:0
    buffer_load_dword v15, v4, s[12:15], 0 offen offset:256
    buffer_load_dword v16, v4, s[12:15], 0 offen offset:512
    buffer_load_dword v17, v4, s[12:15], 0 offen offset:768
    buffer_load_dword v18, v4, s[12:15], 0 offen offset:1024
    buffer_load_dword v19, v4, s[12:15], 0 offen offset:1280
    buffer_load_dword v20, v4, s[12:15], 0 offen offset:1536
    buffer_load_dword v21, v4, s[12:15], 0 offen offset:1792
    buffer_load_dword v22, v4, s[12:15], 0 offen offset:2048
    buffer_load_dword v23, v4, s[12:15], 0 offen offset:2304
    v_add_u32 v4, 40064, v4
    s_add_u32 s8, s20, 0
    s_addc_u32 s9, s21, 0
    s_mov_b32 s10, 3200000
    s_mov_b32 s11, 0x00020000
    v_mov_b32 v85, 0
    v_mov_b32 v86, 0
    v_mov_b32 v87, 0
    s_mov_b64 s[64:65], 0
    s_mov_b64 s[66:67], 0
    v_mov_b32 v8, 40960
    v_mov_b32 v9, 40960
    v_mov_b32 v10, 40960
    s_mov_b32 s35, 0
    s_load_dword s74, s[68:69], 0
    s_load_dword s75, s[80:81], 0
    s_load_dword s76, s[82:83], 0
    s_load_dword s77, s[84:85], 0
    s_load_dword s78, s[86:87], 0
    s_mul_i32 s40, s33, 50000
    s_mul_i32 s41, s34, 12512
    s_add_u32 s40, s40, s41
    v_add_u32 v121, s40, v3
    s_sub_u32 s41, 50000, s41
    s_min_u32 s41, s41, 12512
    v_cmp_gt_u32 s[50:51], s41, v3
    s_mov_b32 s18, 800000
    s_mov_b32 s19, 0x00020000
    v_cndmask_b32 v121, v6, v121, s[50:51]
    v_lshrrev_b32 v122, 2, v121
    v_mov_b32 v30, 0
    v_mov_b32 v31, 0
    v_mov_b32 v32, 0
    v_mov_b32 v33, 0
    v_add_u32 v60, 40960, v3
    v_add_u32 v61, 106496, v3
    ds_write_b128 v60, v[30:33] offset:32768
    ds_write_b128 v60, v[30:33] offset:49152
    ds_write_b128 v61, v[30:33]
    ds_write_b128 v61, v[30:33] offset:16384
    v_cmp_gt_u32 vcc, 106, v0
    s_and_saveexec_b64 s[50:51], vcc
    ds_write_b128 v61, v[30:33] offset:32768
    s_mov_b64 exec, s[50:51]
    s_waitcnt vmcnt(10)
    s_barrier
    ds_read_b128 v[64:67], v56 offset:0
    ds_read_b128 v[68:71], v56 offset:16
    ds_read_b128 v[72:75], v56 offset:32
    ds_read_b128 v[76:79], v56 offset:48
    ds_read_b128 v[80:83], v56 offset:64
    ds_read_b32 v84, v56 offset:80
    v_add_f32 v38, v34, v35
    v_add_f32 v39, v36, v37
    v_add_f32 v38, v38, v39
    v_pk_max_u16 v34, v34, v35
    v_pk_max_u16 v36, v36, v37
    v_pk_max_u16 v34, v34, v36
    v_lshlrev_b32 v34, 16, v34
    s_nop 0
    v_add_f32_dpp v38, v38, v38 row_shr:1 row_mask:0xf bank_mask:0xf
    v_max_u32_dpp v34, v34, v34 row_shr:1 row_mask:0xf bank_mask:0xf
    s_nop 0
    v_add_f32_dpp v38, v38, v38 row_shr:2 row_mask:0xf bank_mask:0xf
    v_max_u32_dpp v34, v34, v34 row_shr:2 row_mask:0xf bank_mask:0xf
    s_nop 0
    v_add_f32_dpp v38, v38, v38 row_shr:4 row_mask:0xf bank_mask:0xf
    v_max_u32_dpp v34, v34, v34 row_shr:4 row_mask:0xf bank_mask:0xf
    s_nop 0
    v_add_f32_dpp v38, v38, v38 row_shr:8 row_mask:0xf bank_mask:0xf
    v_max_u32_dpp v34, v34, v34 row_shr:8 row_mask:0xf bank_mask:0xf
    s_nop 0
    v_add_f32_dpp v38, v38, v38 row_bcast:15 row_mask:0xa bank_mask:0xf
    v_max_u32_dpp v34, v34, v34 row_bcast:15 row_mask:0xa bank_mask:0xf
    s_nop 0
    v_add_f32_dpp v38, v38, v38 row_bcast:31 row_mask:0xc bank_mask:0xf
    v_max_u32_dpp v34, v34, v34 row_bcast:31 row_mask:0xc bank_mask:0xf
    s_nop 0
    v_mul_f32 v38, 0x3fa66666, v38
    v_readlane_b32 s31, v34, 63
    v_readlane_b32 s30, v38, 63
    s_cmp_lt_u32 s32, 4
    s_waitcnt lgkmcnt(0)
    s_cbranch_scc1 k2_rem
    v_and_b32 v56, 0x7fff0, v64
    v_add_u32 v56, v56, v2
    buffer_load_dwordx4 v[88:91], v56, s[4:7], 0 offen
    v_mov_b32 v84, v83
    v_mov_b32 v85, v83
    v_mov_b32 v86, v83
    v_mov_b32 v87, v83
    s_cmp_lt_u32 s32, 10
    s_cbranch_scc1 k2_n2
    v_and_b32 v57, 0x7fff0, v65
    v_add_u32 v57, v57, v2
    buffer_load_dwordx4 v[92:95], v57, s[4:7], 0 offen
    s_waitcnt vmcnt(2)
    s_branch k2_n3
k2_n2:
    s_waitcnt vmcnt(1)
k2_n3:
    s_mov_b32 m0, s101
    s_nop 0
    ds_write_addtid_b32 v14 offset:0
    ds_write_addtid_b32 v15 offset:256
    ds_write_addtid_b32 v16 offset:512
    ds_write_addtid_b32 v17 offset:768
    ds_write_addtid_b32 v18 offset:1024
    ds_write_addtid_b32 v19 offset:1280
    ds_write_addtid_b32 v20 offset:1536
    ds_write_addtid_b32 v21 offset:1792
    ds_write_addtid_b32 v22 offset:2048
    ds_write_addtid_b32 v23 offset:2304
    s_waitcnt lgkmcnt(0)
    s_barrier
    v_add_u32 v42, 40960, v3
    ds_write_b128 v42, v[30:33]
    ds_write_b128 v42, v[30:33] offset:16384
    v_mov_b32 v42, 140960
    ds_read_b128 v[42:45], v42
    s_mov_b32 s41, s31
    s_waitcnt lgkmcnt(0)
    v_add_u32 v42, v42, v43
    v_add_u32 v44, v44, v45
    v_add_u32 v42, v42, v44
    v_lshrrev_b32 v42, 4, v42
    v_mul_u32_u24 v42, 3, v42
    v_max_u32 v42, 1024, v42
    s_nop 0
    v_readfirstlane_b32 s39, v42
    v_cvt_f32_u32 v42, v42
    v_mul_f32 v42, s41, v42
    v_mul_f32 v42, 0x3f802000, v42
    s_nop 0
    v_readfirstlane_b32 s40, v42
    s_mov_b32 s37, 0
    s_cmp_gt_u32 s39, 0x100000
    s_cselect_b32 s37, 1, s37
    s_cmp_gt_u32 s41, 0x70000000
    s_cselect_b32 s37, 1, s37
    s_cmp_lt_u32 s41, 0x18000000
    s_cselect_b32 s37, 1, s37
    s_and_b32 s40, s40, 0x7f800000
    s_cmp_gt_u32 s40, s30
    s_cselect_b32 s37, 1, s37
    s_and_b32 s41, s41, 0x7f800000
    s_sub_u32 s38, s40, s41
    s_add_u32 s3, s41, 50331648
    s_add_u32 s38, s38, 763363328
    s_sub_u32 s40, s40, 54525952
    v_mov_b32 v5, s40
    s_sub_u32 s46, 0, s40
    s_not_b32 s47, s40
    s_barrier
    buffer_load_dword v108, v4, s[12:15], 0 offen offset:0
    buffer_load_dword v109, v4, s[12:15], 0 offen offset:256
    buffer_load_dword v110, v4, s[12:15], 0 offen offset:512
    buffer_load_dword v111, v4, s[12:15], 0 offen offset:768
    buffer_load_dword v112, v4, s[12:15], 0 offen offset:1024
    buffer_load_dword v113, v4, s[12:15], 0 offen offset:1280
    buffer_load_dword v114, v4, s[12:15], 0 offen offset:1536
    buffer_load_dword v115, v4, s[12:15], 0 offen offset:1792
    buffer_load_dword v116, v4, s[12:15], 0 offen offset:2048
    buffer_load_dword v117, v4, s[12:15], 0 offen offset:2304
    v_add_u32 v4, 40064, v4
    s_cmp_lt_u32 s32, 10
    s_cbranch_scc1 k2_dv1
    buffer_load_dword v14, v4, s[12:15], 0 offen offset:0
    buffer_load_dword v15, v4, s[12:15], 0 offen offset:256
    buffer_load_dword v16, v4, s[12:15], 0 offen offset:512
    buffer_load_dword v17, v4, s[12:15], 0 offen offset:768
    s_set_gpr_idx_on s35, 0x1
    v_mov_b32 v57, v64
    s_set_gpr_idx_off
    v_cmp_le_u32 s[56:57], v104, v57
    v_cmp_le_u32 s[58:59], v105, v57
    v_cmp_le_u32 s[60:61], v106, v57
    s_waitcnt vmcnt(15)
    v_alignbit_b32 v118, v88, v89, 19
    v_lshlrev_b32 v119, 10, v89
    v_and_b32 v118, 0xfff8, v118
    v_lshlrev_b32 v120, 20, v89
    v_alignbit_b32 v119, v90, v119, 19
    v_alignbit_b32 v120, v91, v120, 19
    v_and_b32 v119, 0xfff8, v119
    v_and_b32 v120, 0xfff8, v120
k2_dloop0:
    s_mov_b64 exec, s[56:57]
    ds_read_b64 v[24:25], v118
    s_mov_b64 exec, s[58:59]
    ds_read_b64 v[26:27], v119
    s_mov_b64 exec, s[60:61]
    ds_read_b64 v[28:29], v120
    s_setprio 0
    s_mov_b64 exec, -1
    buffer_load_dword v18, v4, s[12:15], 0 offen offset:1024
    buffer_load_dword v19, v4, s[12:15], 0 offen offset:1280
    buffer_load_dword v20, v4, s[12:15], 0 offen offset:1536
    buffer_load_dword v21, v4, s[12:15], 0 offen offset:1792
    buffer_load_dword v22, v4, s[12:15], 0 offen offset:2048
    buffer_load_dword v23, v4, s[12:15], 0 offen offset:2304
    v_add_u32 v4, 40064, v4
    s_set_gpr_idx_on s35, 0x2
    v_and_b32 v58, 0x7fff0, v66
    v_and_b32 v59, 0x7fff0, v67
    s_set_gpr_idx_off
    v_add_u32 v58, v58, v2
    v_add_u32 v59, v59, v2
    v_and_b32 v9, v6, v103
    v_lshlrev_b32 v38, 16, v50
    v_and_b32 v39, v6, v50
    v_lshlrev_b32 v40, 16, v51
    v_and_b32 v41, v6, v51
    v_fma_f32 v38, v38, v9, v5
    v_fma_f32 v39, v39, v9, v5
    v_fma_f32 v40, v40, v9, v5
    v_fma_f32 v41, v41, v9, v5
    v_and_b32 v9, 0xfff8, v103
    v_lshl_add_u64 v[38:39], v[38:39], 0, s[46:47]
    v_add_u32 v9, 40960, v9
    v_lshl_add_u64 v[40:41], v[40:41], 0, s[46:47]
    s_mov_b64 exec, s[66:67]
    ds_add_u64 v9, v[38:39]
    ds_add_u64 v9, v[40:41] offset:50000
    s_mov_b64 exec, -1
    s_cmp_eq_u64 s[66:67], 0
    s_cbranch_scc1 k2_wz_da00
k2_w_da00:
    s_setprio 3
    s_waitcnt lgkmcnt(2)
    s_barrier
    s_waitcnt vmcnt(10)
    buffer_load_dwordx4 v[96:99], v58, s[4:7], 0 offen
    buffer_load_dwordx4 v[100:103], v59, s[4:7], 0 offen
    s_mov_b32 m0, s101
    s_nop 0
    ds_write_addtid_b32 v108 offset:0
    ds_write_addtid_b32 v109 offset:256
    ds_write_addtid_b32 v110 offset:512
    ds_write_addtid_b32 v111 offset:768
    ds_write_addtid_b32 v112 offset:1024
    ds_write_addtid_b32 v113 offset:1280
    ds_write_addtid_b32 v114 offset:1536
    ds_write_addtid_b32 v115 offset:1792
    ds_write_addtid_b32 v116 offset:2048
    ds_write_addtid_b32 v117 offset:2304
    s_setprio 0
    s_cmp_lg_u32 s37, 0
    s_cbranch_scc1 k2_accf_d00
    v_and_b32 v10, v6, v88
    v_lshlrev_b32 v30, 16, v24
    v_and_b32 v31, v6, v24
    v_lshlrev_b32 v32, 16, v25
    v_and_b32 v33, v6, v25
    v_fma_f32 v30, v30, v10, v5
    v_fma_f32 v31, v31, v10, v5
    v_fma_f32 v32, v32, v10, v5
    v_fma_f32 v33, v33, v10, v5
    v_and_b32 v10, 0xfff8, v88
    v_lshl_add_u64 v[30:31], v[30:31], 0, s[46:47]
    v_add_u32 v10, 40960, v10
    v_lshl_add_u64 v[32:33], v[32:33], 0, s[46:47]
    s_mov_b64 exec, s[56:57]
    ds_add_u64 v10, v[30:31]
    ds_add_u64 v10, v[32:33] offset:50000
    s_mov_b64 exec, -1
    buffer_load_dword v108, v4, s[12:15], 0 offen offset:0
    buffer_load_dword v109, v4, s[12:15], 0 offen offset:256
    buffer_load_dword v110, v4, s[12:15], 0 offen offset:512
    buffer_load_dword v111, v4, s[12:15], 0 offen offset:768
    v_and_b32 v8, v6, v90
    v_lshlrev_b32 v34, 16, v26
    v_and_b32 v35, v6, v26
    v_lshlrev_b32 v36, 16, v27
    v_and_b32 v37, v6, v27
    v_fma_f32 v34, v34, v8, v5
    v_fma_f32 v35, v35, v8, v5
    v_fma_f32 v36, v36, v8, v5
    v_fma_f32 v37, v37, v8, v5
    v_and_b32 v8, 0xfff8, v90
    v_lshl_add_u64 v[34:35], v[34:35], 0, s[46:47]
    v_add_u32 v8, 40960, v8
    v_lshl_add_u64 v[36:37], v[36:37], 0, s[46:47]
k2_acce_d00:
    s_set_gpr_idx_on s35, 0x1
    v_mov_b32 v57, v65
    s_set_gpr_idx_off
    v_cmp_le_u32 s[62:63], v104, v57
    v_cmp_le_u32 s[64:65], v105, v57
    v_cmp_le_u32 s[66:67], v106, v57
    v_alignbit_b32 v118, v92, v93, 19
    v_lshlrev_b32 v119, 10, v93
    v_and_b32 v118, 0xfff8, v118
    v_lshlrev_b32 v120, 20, v93
    v_alignbit_b32 v119, v94, v119, 19
    v_alignbit_b32 v120, v95, v120, 19
    v_and_b32 v119, 0xfff8, v119
    v_and_b32 v120, 0xfff8, v120
    s_mov_b64 exec, s[58:59]
    ds_add_u64 v8, v[34:35]
    ds_add_u64 v8, v[36:37] offset:50000
    s_mov_b64 exec, -1
    s_cmp_eq_u64 s[58:59], 0
    s_cbranch_scc1 k2_wz_db00
k2_w_db00:
    s_setprio 3
    s_waitcnt lgkmcnt(4)
    s_barrier
    s_mov_b64 exec, s[62:63]
    ds_read_b64 v[24:25], v118
    s_mov_b64 exec, s[64:65]
    ds_read_b64 v[26:27], v119
    s_mov_b64 exec, s[66:67]
    ds_read_b64 v[50:51], v120
    s_setprio 0
    s_mov_b64 exec, -1
    buffer_load_dword v112, v4, s[12:15], 0 offen offset:1024
    buffer_load_dword v113, v4, s[12:15], 0 offen offset:1280
    buffer_load_dword v114, v4, s[12:15], 0 offen offset:1536
    buffer_load_dword v115, v4, s[12:15], 0 offen offset:1792
    buffer_load_dword v116, v4, s[12:15], 0 offen offset:2048
    buffer_load_dword v117, v4, s[12:15], 0 offen offset:2304
    v_add_u32 v4, 40064, v4
    v_and_b32 v9, v6, v91
    v_lshlrev_b32 v38, 16, v28
    v_and_b32 v39, v6, v28
    v_lshlrev_b32 v40, 16, v29
    v_and_b32 v41, v6, v29
    v_fma_f32 v38, v38, v9, v5
    v_fma_f32 v39, v39, v9, v5
    v_fma_f32 v40, v40, v9, v5
    v_fma_f32 v41, v41, v9, v5
    v_and_b32 v9, 0xfff8, v91
    v_lshl_add_u64 v[38:39], v[38:39], 0, s[46:47]
    v_add_u32 v9, 40960, v9
    v_lshl_add_u64 v[40:41], v[40:41], 0, s[46:47]
    s_mov_b64 exec, s[60:61]
    ds_add_u64 v9, v[38:39]
    ds_add_u64 v9, v[40:41] offset:50000
    s_mov_b64 exec, -1
    s_cmp_eq_u64 s[60:61], 0
    s_cbranch_scc1 k2_wz_da01
k2_w_da01:
    s_setprio 3
    s_waitcnt lgkmcnt(2)
    s_barrier
    s_waitcnt vmcnt(12)
    s_mov_b32 m0, s101
    s_nop 0
    ds_write_addtid_b32 v14 offset:0
    ds_write_addtid_b32 v15 offset:256
    ds_write_addtid_b32 v16 offset:512
    ds_write_addtid_b32 v17 offset:768
    ds_write_addtid_b32 v18 offset:1024
    ds_write_addtid_b32 v19 offset:1280
    ds_write_addtid_b32 v20 offset:1536
    ds_write_addtid_b32 v21 offset:1792
    ds_write_addtid_b32 v22 offset:2048
    ds_write_addtid_b32 v23 offset:2304
    s_setprio 0
    s_cmp_lg_u32 s37, 0
    s_cbranch_scc1 k2_accf_d01
    v_and_b32 v10, v6, v92
    v_lshlrev_b32 v30, 16, v24
    v_and_b32 v31, v6, v24
    v_lshlrev_b32 v32, 16, v25
    v_and_b32 v33, v6, v25
    v_fma_f32 v30, v30, v10, v5
    v_fma_f32 v31, v31, v10, v5
    v_fma_f32 v32, v32, v10, v5
    v_fma_f32 v33, v33, v10, v5
    v_and_b32 v10, 0xfff8, v92
    v_lshl_add_u64 v[30:31], v[30:31], 0, s[46:47]
    v_add_u32 v10, 40960, v10
    v_lshl_add_u64 v[32:33], v[32:33], 0, s[46:47]
    s_mov_b64 exec, s[62:63]
    ds_add_u64 v10, v[30:31]
    ds_add_u64 v10, v[32:33] offset:50000
    s_mov_b64 exec, -1
    buffer_load_dword v14, v4, s[12:15], 0 offen offset:0
    buffer_load_dword v15, v4, s[12:15], 0 offen offset:256
    buffer_load_dword v16, v4, s[12:15], 0 offen offset:512
    buffer_load_dword v17, v4, s[12:15], 0 offen offset:768
    v_and_b32 v8, v6, v94
    v_lshlrev_b32 v34, 16, v26
    v_and_b32 v35, v6, v26
    v_lshlrev_b32 v36, 16, v27
    v_and_b32 v37, v6, v27
    v_fma_f32 v34, v34, v8, v5
    v_fma_f32 v35, v35, v8, v5
    v_fma_f32 v36, v36, v8, v5
    v_fma_f32 v37, v37, v8, v5
    v_and_b32 v8, 0xfff8, v94
    v_lshl_add_u64 v[34:35], v[34:35], 0, s[46:47]
    v_add_u32 v8, 40960, v8
    v_lshl_add_u64 v[36:37], v[36:37], 0, s[46:47]
k2_acce_d01:
    s_cmp_eq_u32 s35, 16
    s_cbranch_scc1 k2_ey_d0
k2_en_d0:
    s_set_gpr_idx_on s35, 0x1
    v_mov_b32 v57, v66
    s_set_gpr_idx_off
    v_cmp_le_u32 s[56:57], v104, v57
    v_cmp_le_u32 s[58:59], v105, v57
    v_cmp_le_u32 s[60:61], v106, v57
    s_waitcnt vmcnt(15)
    v_alignbit_b32 v118, v96, v97, 19
    v_lshlrev_b32 v119, 10, v97
    v_and_b32 v118, 0xfff8, v118
    v_lshlrev_b32 v120, 20, v97
    v_alignbit_b32 v119, v98, v119, 19
    v_alignbit_b32 v120, v99, v120, 19
    v_and_b32 v119, 0xfff8, v119
    v_and_b32 v120, 0xfff8, v120
    s_mov_b64 exec, s[64:65]
    ds_add_u64 v8, v[34:35]
    ds_add_u64 v8, v[36:37] offset:50000
    s_mov_b64 exec, -1
    s_cmp_eq_u64 s[64:65], 0
    s_cbranch_scc1 k2_wz_db01
k2_w_db01:
    s_setprio 3
    s_waitcnt lgkmcnt(4)
    s_barrier
    s_mov_b64 exec, s[56:57]
    ds_read_b64 v[24:25], v118
    s_mov_b64 exec, s[58:59]
    ds_read_b64 v[26:27], v119
    s_mov_b64 exec, s[60:61]
    ds_read_b64 v[28:29], v120
    s_setprio 0
    s_mov_b64 exec, -1
    buffer_load_dword v18, v4, s[12:15], 0 offen offset:1024
    buffer_load_dword v19, v4, s[12:15], 0 offen offset:1280
    buffer_load_dword v20, v4, s[12:15], 0 offen offset:1536
    buffer_load_dword v21, v4, s[12:15], 0 offen offset:1792
    buffer_load_dword v22, v4, s[12:15], 0 offen offset:2048
    buffer_load_dword v23, v4, s[12:15], 0 offen offset:2304
    v_add_u32 v4, 40064, v4
    s_set_gpr_idx_on s35, 0x2
    v_and_b32 v58, 0x7fff0, v68
    v_and_b32 v59, 0x7fff0, v69
    s_set_gpr_idx_off
    v_add_u32 v58, v58, v2
    v_add_u32 v59, v59, v2
    v_and_b32 v9, v6, v95
    v_lshlrev_b32 v38, 16, v50
    v_and_b32 v39, v6, v50
    v_lshlrev_b32 v40, 16, v51
    v_and_b32 v41, v6, v51
    v_fma_f32 v38, v38, v9, v5
    v_fma_f32 v39, v39, v9, v5
    v_fma_f32 v40, v40, v9, v5
    v_fma_f32 v41, v41, v9, v5
    v_and_b32 v9, 0xfff8, v95
    v_lshl_add_u64 v[38:39], v[38:39], 0, s[46:47]
    v_add_u32 v9, 40960, v9
    v_lshl_add_u64 v[40:41], v[40:41], 0, s[46:47]
    s_mov_b64 exec, s[66:67]
    ds_add_u64 v9, v[38:39]
    ds_add_u64 v9, v[40:41] offset:50000
    s_mov_b64 exec, -1
    s_cmp_eq_u64 s[66:67], 0
    s_cbranch_scc1 k2_wz_da02
k2_w_da02:
    s_setprio 3
    s_waitcnt lgkmcnt(2)
    s_barrier
    s_waitcnt vmcnt(10)
    buffer_load_dwordx4 v[88:91], v58, s[4:7], 0 offen
    buffer_load_dwordx4 v[92:95], v59, s[4:7], 0 offen
    s_mov_b32 m0, s101
    s_nop 0
    ds_write_addtid_b32 v108 offset:0
    ds_write_addtid_b32 v109 offset:256
    ds_write_addtid_b32 v110 offset:512
    ds_write_addtid_b32 v111 offset:768
    ds_write_addtid_b32 v112 offset:1024
    ds_write_addtid_b32 v113 offset:1280
    ds_write_addtid_b32 v114 offset:1536
    ds_write_addtid_b32 v115 offset:1792
    ds_write_addtid_b32 v116 offset:2048
    ds_write_addtid_b32 v117 offset:2304
    s_setprio 0
    s_cmp_lg_u32 s37, 0
    s_cbranch_scc1 k2_accf_d02
    v_and_b32 v10, v6, v96
    v_lshlrev_b32 v30, 16, v24
    v_and_b32 v31, v6, v24
    v_lshlrev_b32 v32, 16, v25
    v_and_b32 v33, v6, v25
    v_fma_f32 v30, v30, v10, v5
    v_fma_f32 v31, v31, v10, v5
    v_fma_f32 v32, v32, v10, v5
    v_fma_f32 v33, v33, v10, v5
    v_and_b32 v10, 0xfff8, v96
    v_lshl_add_u64 v[30:31], v[30:31], 0, s[46:47]
    v_add_u32 v10, 40960, v10
    v_lshl_add_u64 v[32:33], v[32:33], 0, s[46:47]
    s_mov_b64 exec, s[56:57]
    ds_add_u64 v10, v[30:31]
    ds_add_u64 v10, v[32:33] offset:50000
    s_mov_b64 exec, -1
    buffer_load_dword v108, v4, s[12:15], 0 offen offset:0
    buffer_load_dword v109, v4, s[12:15], 0 offen offset:256
    buffer_load_dword v110, v4, s[12:15], 0 offen offset:512
    buffer_load_dword v111, v4, s[12:15], 0 offen offset:768
    v_and_b32 v8, v6, v98
    v_lshlrev_b32 v34, 16, v26
    v_and_b32 v35, v6, v26
    v_lshlrev_b32 v36, 16, v27
    v_and_b32 v37, v6, v27
    v_fma_f32 v34, v34, v8, v5
    v_fma_f32 v35, v35, v8, v5
    v_fma_f32 v36, v36, v8, v5
    v_fma_f32 v37, v37, v8, v5
    v_and_b32 v8, 0xfff8, v98
    v_lshl_add_u64 v[34:35], v[34:35], 0, s[46:47]
    v_add_u32 v8, 40960, v8
    v_lshl_add_u64 v[36:37], v[36:37], 0, s[46:47]
k2_acce_d02:
    s_set_gpr_idx_on s35, 0x1
    v_mov_b32 v57, v67
    s_set_gpr_idx_off
    v_cmp_le_u32 s[62:63], v104, v57
    v_cmp_le_u32 s[64:65], v105, v57
    v_cmp_le_u32 s[66:67], v106, v57
    v_alignbit_b32 v118, v100, v101, 19
    v_lshlrev_b32 v119, 10, v101
    v_and_b32 v118, 0xfff8, v118
    v_lshlrev_b32 v120, 20, v101
    v_alignbit_b32 v119, v102, v119, 19
    v_alignbit_b32 v120, v103, v120, 19
    v_and_b32 v119, 0xfff8, v119
    v_and_b32 v120, 0xfff8, v120
    s_mov_b64 exec, s[58:59]
    ds_add_u64 v8, v[34:35]
    ds_add_u64 v8, v[36:37] offset:50000
    s_mov_b64 exec, -1
    s_cmp_eq_u64 s[58:59], 0
    s_cbranch_scc1 k2_wz_db02
k2_w_db02:
    s_setprio 3
    s_waitcnt lgkmcnt(4)
    s_barrier
    s_mov_b64 exec, s[62:63]
    ds_read_b64 v[24:25], v118
    s_mov_b64 exec, s[64:65]
    ds_read_b64 v[26:27], v119
    s_mov_b64 exec, s[66:67]
    ds_read_b64 v[50:51], v120
    s_setprio 0
    s_mov_b64 exec, -1
    buffer_load_dword v112, v4, s[12:15], 0 offen offset:1024
    buffer_load_dword v113, v4, s[12:15], 0 offen offset:1280
    buffer_load_dword v114, v4, s[12:15], 0 offen offset:1536
    buffer_load_dword v115, v4, s[12:15], 0 offen offset:1792
    buffer_load_dword v116, v4, s[12:15], 0 offen offset:2048
    buffer_load_dword v117, v4, s[12:15], 0 offen offset:2304
    v_add_u32 v4, 40064, v4
    v_and_b32 v9, v6, v99
    v_lshlrev_b32 v38, 16, v28
    v_and_b32 v39, v6, v28
    v_lshlrev_b32 v40, 16, v29
    v_and_b32 v41, v6, v29
    v_fma_f32 v38, v38, v9, v5
    v_fma_f32 v39, v39, v9, v5
    v_fma_f32 v40, v40, v9, v5
    v_fma_f32 v41, v41, v9, v5
    v_and_b32 v9, 0xfff8, v99
    v_lshl_add_u64 v[38:39], v[38:39], 0, s[46:47]
    v_add_u32 v9, 40960, v9
    v_lshl_add_u64 v[40:41], v[40:41], 0, s[46:47]
    s_mov_b64 exec, s[60:61]
    ds_add_u64 v9, v[38:39]
    ds_add_u64 v9, v[40:41] offset:50000
    s_mov_b64 exec, -1
    s_cmp_eq_u64 s[60:61], 0
    s_cbranch_scc1 k2_wz_da03
k2_w_da03:
    s_setprio 3
    s_waitcnt lgkmcnt(2)
    s_barrier
    s_waitcnt vmcnt(12)
    s_mov_b32 m0, s101
    s_nop 0
    ds_write_addtid_b32 v14 offset:0
    ds_write_addtid_b32 v15 offset:256
    ds_write_addtid_b32 v16 offset:512
    ds_write_addtid_b32 v17 offset:768
    ds_write_addtid_b32 v18 offset:1024
    ds_write_addtid_b32 v19 offset:1280
    ds_write_addtid_b32 v20 offset:1536
    ds_write_addtid_b32 v21 offset:1792
    ds_write_addtid_b32 v22 offset:2048
    ds_write_addtid_b32 v23 offset:2304
    s_setprio 0
    s_cmp_lg_u32 s37, 0
    s_cbranch_scc1 k2_accf_d03
    v_and_b32 v10, v6, v100
    v_lshlrev_b32 v30, 16, v24
    v_and_b32 v31, v6, v24
    v_lshlrev_b32 v32, 16, v25
    v_and_b32 v33, v6, v25
    v_fma_f32 v30, v30, v10, v5
    v_fma_f32 v31, v31, v10, v5
    v_fma_f32 v32, v32, v10, v5
    v_fma_f32 v33, v33, v10, v5
    v_and_b32 v10, 0xfff8, v100
    v_lshl_add_u64 v[30:31], v[30:31], 0, s[46:47]
    v_add_u32 v10, 40960, v10
    v_lshl_add_u64 v[32:33], v[32:33], 0, s[46:47]
    s_mov_b64 exec, s[62:63]
    ds_add_u64 v10, v[30:31]
    ds_add_u64 v10, v[32:33] offset:50000
    s_mov_b64 exec, -1
    buffer_load_dword v14, v4, s[12:15], 0 offen offset:0
    buffer_load_dword v15, v4, s[12:15], 0 offen offset:256
    buffer_load_dword v16, v4, s[12:15], 0 offen offset:512
    buffer_load_dword v17, v4, s[12:15], 0 offen offset:768
    v_and_b32 v8, v6, v102
    v_lshlrev_b32 v34, 16, v26
    v_and_b32 v35, v6, v26
    v_lshlrev_b32 v36, 16, v27
    v_and_b32 v37, v6, v27
    v_fma_f32 v34, v34, v8, v5
    v_fma_f32 v35, v35, v8, v5
    v_fma_f32 v36, v36, v8, v5
    v_fma_f32 v37, v37, v8, v5
    v_and_b32 v8, 0xfff8, v102
    v_lshl_add_u64 v[34:35], v[34:35], 0, s[46:47]
    v_add_u32 v8, 40960, v8
    v_lshl_add_u64 v[36:37], v[36:37], 0, s[46:47]
k2_acce_d03:
    s_set_gpr_idx_on s35, 0x1
    v_mov_b32 v57, v68
    s_set_gpr_idx_off
    v_cmp_le_u32 s[56:57], v104, v57
    v_cmp_le_u32 s[58:59], v105, v57
    v_cmp_le_u32 s[60:61], v106, v57
    s_waitcnt vmcnt(15)
    v_alignbit_b32 v118, v88, v89, 19
    v_lshlrev_b32 v119, 10, v89
    v_and_b32 v118, 0xfff8, v118
    v_lshlrev_b32 v120, 20, v89
    v_alignbit_b32 v119, v90, v119, 19
    v_alignbit_b32 v120, v91, v120, 19
    v_and_b32 v119, 0xfff8, v119
    v_and_b32 v120, 0xfff8, v120
    s_add_u32 s35, s35, 4
    s_mov_b64 exec, s[64:65]
    ds_add_u64 v8, v[34:35]
    ds_add_u64 v8, v[36:37] offset:50000
    s_mov_b64 exec, -1
    s_cmp_eq_u64 s[64:65], 0
    s_cbranch_scc1 k2_wz_db03
k2_w_db03:
    s_setprio 3
    s_waitcnt lgkmcnt(4)
    s_barrier
    s_cmp_lt_u32 s35, 20
    s_cbranch_scc1 k2_dloop0
    s_branch k2_dend
k2_dv1:
    v_and_b32 v56, 0x7fff0, v65
    v_add_u32 v56, v56, v2
    buffer_load_dwordx4 v[92:95], v56, s[4:7], 0 offen
    v_and_b32 v57, 0x7fff0, v66
    v_add_u32 v57, v57, v2
    buffer_load_dwordx4 v[96:99], v57, s[4:7], 0 offen
    buffer_load_dword v14, v4, s[12:15], 0 offen offset:0
    buffer_load_dword v15, v4, s[12:15], 0 offen offset:256
    buffer_load_dword v16, v4, s[12:15], 0 offen offset:512
    buffer_load_dword v17, v4, s[12:15], 0 offen offset:768
    s_set_gpr_idx_on s35, 0x1
    v_mov_b32 v57, v64
    s_set_gpr_idx_off
    v_cmp_le_u32 s[56:57], v104, v57
    v_cmp_le_u32 s[58:59], v105, v57
    v_cmp_le_u32 s[60:61], v106, v57
    s_waitcnt vmcnt(16)
    v_alignbit_b32 v118, v88, v89, 19
    v_lshlrev_b32 v119, 10, v89
    v_and_b32 v118, 0xfff8, v118
    v_lshlrev_b32 v120, 20, v89
    v_alignbit_b32 v119, v90, v119, 19
    v_alignbit_b32 v120, v91, v120, 19
    v_and_b32 v119, 0xfff8, v119
    v_and_b32 v120, 0xfff8, v120
k2_dloop1:
    s_mov_b64 exec, s[56:57]
    ds_read_b64 v[24:25], v118
    s_mov_b64 exec, s[58:59]
    ds_read_b64 v[26:27], v119
    s_mov_b64 exec, s[60:61]
    ds_read_b64 v[28:29], v120
    s_setprio 0
    s_mov_b64 exec, -1
    buffer_load_dword v18, v4, s[12:15], 0 offen offset:1024
    buffer_load_dword v19, v4, s[12:15], 0 offen offset:1280
    buffer_load_dword v20, v4, s[12:15], 0 offen offset:1536
    buffer_load_dword v21, v4, s[12:15], 0 offen offset:1792
    buffer_load_dword v22, v4, s[12:15], 0 offen offset:2048
    buffer_load_dword v23, v4, s[12:15], 0 offen offset:2304
    v_add_u32 v4, 40064, v4
    v_and_b32 v9, v6, v103
    v_lshlrev_b32 v38, 16, v50
    v_and_b32 v39, v6, v50
    v_lshlrev_b32 v40, 16, v51
    v_and_b32 v41, v6, v51
    v_fma_f32 v38, v38, v9, v5
    v_fma_f32 v39, v39, v9, v5
    v_fma_f32 v40, v40, v9, v5
    v_fma_f32 v41, v41, v9, v5
    v_and_b32 v9, 0xfff8, v103
    v_lshl_add_u64 v[38:39], v[38:39], 0, s[46:47]
    v_add_u32 v9, 40960, v9
    v_lshl_add_u64 v[40:41], v[40:41], 0, s[46:47]
    s_mov_b64 exec, s[66:67]
    ds_add_u64 v9, v[38:39]
    ds_add_u64 v9, v[40:41] offset:50000
    s_mov_b64 exec, -1
    s_cmp_eq_u64 s[66:67], 0
    s_cbranch_scc1 k2_wz_da10
k2_w_da10:
    s_setprio 3
    s_waitcnt lgkmcnt(2)
    v_and_b32 v10, v6, v88
    v_lshlrev_b32 v30, 16, v24
    v_and_b32 v31, v6, v24
    v_lshlrev_b32 v32, 16, v25
    v_and_b32 v33, v6, v25
    v_fma_f32 v30, v30, v10, v5
    v_fma_f32 v31, v31, v10, v5
    v_fma_f32 v32, v32, v10, v5
    v_fma_f32 v33, v33, v10, v5
    v_and_b32 v10, 0xfff8, v88
    v_lshl_add_u64 v[30:31], v[30:31], 0, s[46:47]
    v_add_u32 v10, 40960, v10
    v_lshl_add_u64 v[32:33], v[32:33], 0, s[46:47]
    s_barrier
    s_waitcnt vmcnt(12)
    s_mov_b32 m0, s101
    s_nop 0
    ds_write_addtid_b32 v108 offset:0
    ds_write_addtid_b32 v109 offset:256
    ds_write_addtid_b32 v110 offset:512
    ds_write_addtid_b32 v111 offset:768
    ds_write_addtid_b32 v112 offset:1024
    ds_write_addtid_b32 v113 offset:1280
    ds_write_addtid_b32 v114 offset:1536
    ds_write_addtid_b32 v115 offset:1792
    ds_write_addtid_b32 v116 offset:2048
    ds_write_addtid_b32 v117 offset:2304
    s_setprio 0
    s_cmp_lg_u32 s37, 0
    s_cbranch_scc1 k2_accf_d10
    s_mov_b64 exec, s[56:57]
    ds_add_u64 v10, v[30:31]
    ds_add_u64 v10, v[32:33] offset:50000
    s_mov_b64 exec, -1
    buffer_load_dword v108, v4, s[12:15], 0 offen offset:0
    buffer_load_dword v109, v4, s[12:15], 0 offen offset:256
    buffer_load_dword v110, v4, s[12:15], 0 offen offset:512
    buffer_load_dword v111, v4, s[12:15], 0 offen offset:768
    v_and_b32 v8, v6, v90
    v_lshlrev_b32 v34, 16, v26
    v_and_b32 v35, v6, v26
    v_lshlrev_b32 v36, 16, v27
    v_and_b32 v37, v6, v27
    v_fma_f32 v34, v34, v8, v5
    v_fma_f32 v35, v35, v8, v5
    v_fma_f32 v36, v36, v8, v5
    v_fma_f32 v37, v37, v8, v5
    v_and_b32 v8, 0xfff8, v90
    v_lshl_add_u64 v[34:35], v[34:35], 0, s[46:47]
    v_add_u32 v8, 40960, v8
    v_lshl_add_u64 v[36:37], v[36:37], 0, s[46:47]
k2_acce_d10:
    s_set_gpr_idx_on s35, 0x1
    v_mov_b32 v57, v65
    s_set_gpr_idx_off
    v_cmp_le_u32 s[62:63], v104, v57
    v_cmp_le_u32 s[64:65], v105, v57
    v_cmp_le_u32 s[66:67], v106, v57
    s_waitcnt vmcnt(15)
    v_alignbit_b32 v118, v92, v93, 19
    v_lshlrev_b32 v119, 10, v93
    v_and_b32 v118, 0xfff8, v118
    v_lshlrev_b32 v120, 20, v93
    v_alignbit_b32 v119, v94, v119, 19
    v_alignbit_b32 v120, v95, v120, 19
    v_and_b32 v119, 0xfff8, v119
    v_and_b32 v120, 0xfff8, v120
    s_mov_b64 exec, s[58:59]
    ds_add_u64 v8, v[34:35]
    ds_add_u64 v8, v[36:37] offset:50000
    s_mov_b64 exec, -1
    s_cmp_eq_u64 s[58:59], 0
    s_cbranch_scc1 k2_wz_db10
k2_w_db10:
    s_setprio 3
    s_waitcnt lgkmcnt(4)
    s_barrier
    s_mov_b64 exec, s[62:63]
    ds_read_b64 v[24:25], v118
    s_mov_b64 exec, s[64:65]
    ds_read_b64 v[26:27], v119
    s_mov_b64 exec, s[66:67]
    ds_read_b64 v[50:51], v120
    s_setprio 0
    s_mov_b64 exec, -1
    buffer_load_dword v112, v4, s[12:15], 0 offen offset:1024
    buffer_load_dword v113, v4, s[12:15], 0 offen offset:1280
    buffer_load_dword v114, v4, s[12:15], 0 offen offset:1536
    buffer_load_dword v115, v4, s[12:15], 0 offen offset:1792
    buffer_load_dword v116, v4, s[12:15], 0 offen offset:2048
    buffer_load_dword v117, v4, s[12:15], 0 offen offset:2304
    v_add_u32 v4, 40064, v4
    s_set_gpr_idx_on s35, 0x2
    v_and_b32 v58, 0x7fff0, v67
    v_and_b32 v59, 0x7fff0, v68
    s_set_gpr_idx_off
    v_add_u32 v58, v58, v2
    v_add_u32 v59, v59, v2
    v_and_b32 v9, v6, v91
    v_lshlrev_b32 v38, 16, v28
    v_and_b32 v39, v6, v28
    v_lshlrev_b32 v40, 16, v29
    v_and_b32 v41, v6, v29
    v_fma_f32 v38, v38, v9, v5
    v_fma_f32 v39, v39, v9, v5
    v_fma_f32 v40, v40, v9, v5
    v_fma_f32 v41, v41, v9, v5
    v_and_b32 v9, 0xfff8, v91
    v_lshl_add_u64 v[38:39], v[38:39], 0, s[46:47]
    v_add_u32 v9, 40960, v9
    v_lshl_add_u64 v[40:41], v[40:41], 0, s[46:47]
    s_mov_b64 exec, s[60:61]
    ds_add_u64 v9, v[38:39]
    ds_add_u64 v9, v[40:41] offset:50000
    s_mov_b64 exec, -1
    s_cmp_eq_u64 s[60:61], 0
    s_cbranch_scc1 k2_wz_da11
k2_w_da11:
    s_setprio 3
    s_waitcnt lgkmcnt(2)
    v_and_b32 v10, v6, v92
    v_lshlrev_b32 v30, 16, v24
    v_and_b32 v31, v6, v24
    v_lshlrev_b32 v32, 16, v25
    v_and_b32 v33, v6, v25
    v_fma_f32 v30, v30, v10, v5
    v_fma_f32 v31, v31, v10, v5
    v_fma_f32 v32, v32, v10, v5
    v_fma_f32 v33, v33, v10, v5
    v_and_b32 v10, 0xfff8, v92
    v_lshl_add_u64 v[30:31], v[30:31], 0, s[46:47]
    v_add_u32 v10, 40960, v10
    v_lshl_add_u64 v[32:33], v[32:33], 0, s[46:47]
    s_barrier
    s_waitcnt vmcnt(10)
    buffer_load_dwordx4 v[100:103], v58, s[4:7], 0 offen
    buffer_load_dwordx4 v[88:91], v59, s[4:7], 0 offen
    s_mov_b32 m0, s101
    s_nop 0
    ds_write_addtid_b32 v14 offset:0
    ds_write_addtid_b32 v15 offset:256
    ds_write_addtid_b32 v16 offset:512
    ds_write_addtid_b32 v17 offset:768
    ds_write_addtid_b32 v18 offset:1024
    ds_write_addtid_b32 v19 offset:1280
    ds_write_addtid_b32 v20 offset:1536
    ds_write_addtid_b32 v21 offset:1792
    ds_write_addtid_b32 v22 offset:2048
    ds_write_addtid_b32 v23 offset:2304
    s_setprio 0
    s_cmp_lg_u32 s37, 0
    s_cbranch_scc1 k2_accf_d11
    s_mov_b64 exec, s[62:63]
    ds_add_u64 v10, v[30:31]
    ds_add_u64 v10, v[32:33] offset:50000
    s_mov_b64 exec, -1
    buffer_load_dword v14, v4, s[12:15], 0 offen offset:0
    buffer_load_dword v15, v4, s[12:15], 0 offen offset:256
    buffer_load_dword v16, v4, s[12:15], 0 offen offset:512
    buffer_load_dword v17, v4, s[12:15], 0 offen offset:768
    v_and_b32 v8, v6, v94
    v_lshlrev_b32 v34, 16, v26
    v_and_b32 v35, v6, v26
    v_lshlrev_b32 v36, 16, v27
    v_and_b32 v37, v6, v27
    v_fma_f32 v34, v34, v8, v5
    v_fma_f32 v35, v35, v8, v5
    v_fma_f32 v36, v36, v8, v5
    v_fma_f32 v37, v37, v8, v5
    v_and_b32 v8, 0xfff8, v94
    v_lshl_add_u64 v[34:35], v[34:35], 0, s[46:47]
    v_add_u32 v8, 40960, v8
    v_lshl_add_u64 v[36:37], v[36:37], 0, s[46:47]
k2_acce_d11:
    s_cmp_eq_u32 s35, 16
    s_cbranch_scc1 k2_ey_d1
k2_en_d1:
    s_set_gpr_idx_on s35, 0x1
    v_mov_b32 v57, v66
    s_set_gpr_idx_off
    v_cmp_le_u32 s[56:57], v104, v57
    v_cmp_le_u32 s[58:59], v105, v57
    v_cmp_le_u32 s[60:61], v106, v57
    v_alignbit_b32 v118, v96, v97, 19
    v_lshlrev_b32 v119, 10, v97
    v_and_b32 v118, 0xfff8, v118
    v_lshlrev_b32 v120, 20, v97
    v_alignbit_b32 v119, v98, v119, 19
    v_alignbit_b32 v120, v99, v120, 19
    v_and_b32 v119, 0xfff8, v119
    v_and_b32 v120, 0xfff8, v120
    s_mov_b64 exec, s[64:65]
    ds_add_u64 v8, v[34:35]
    ds_add_u64 v8, v[36:37] offset:50000
    s_mov_b64 exec, -1
    s_cmp_eq_u64 s[64:65], 0
    s_cbranch_scc1 k2_wz_db11
k2_w_db11:
    s_setprio 3
    s_waitcnt lgkmcnt(4)
    s_barrier
    s_mov_b64 exec, s[56:57]
    ds_read_b64 v[24:25], v118
    s_mov_b64 exec, s[58:59]
    ds_read_b64 v[26:27], v119
    s_mov_b64 exec, s[60:61]
    ds_read_b64 v[28:29], v120
    s_setprio 0
    s_mov_b64 exec, -1
    buffer_load_dword v18, v4, s[12:15], 0 offen offset:1024
    buffer_load_dword v19, v4, s[12:15], 0 offen offset:1280
    buffer_load_dword v20, v4, s[12:15], 0 offen offset:1536
    buffer_load_dword v21, v4, s[12:15], 0 offen offset:1792
    buffer_load_dword v22, v4, s[12:15], 0 offen offset:2048
    buffer_load_dword v23, v4, s[12:15], 0 offen offset:2304
    v_add_u32 v4, 40064, v4
    v_and_b32 v9, v6, v95
    v_lshlrev_b32 v38, 16, v50
    v_and_b32 v39, v6, v50
    v_lshlrev_b32 v40, 16, v51
    v_and_b32 v41, v6, v51
    v_fma_f32 v38, v38, v9, v5
    v_fma_f32 v39, v39, v9, v5
    v_fma_f32 v40, v40, v9, v5
    v_fma_f32 v41, v41, v9, v5
    v_and_b32 v9, 0xfff8, v95
    v_lshl_add_u64 v[38:39], v[38:39], 0, s[46:47]
    v_add_u32 v9, 40960, v9
    v_lshl_add_u64 v[40:41], v[40:41], 0, s[46:47]
    s_mov_b64 exec, s[66:67]
    ds_add_u64 v9, v[38:39]
    ds_add_u64 v9, v[40:41] offset:50000
    s_mov_b64 exec, -1
    s_cmp_eq_u64 s[66:67], 0
    s_cbranch_scc1 k2_wz_da12
k2_w_da12:
    s_setprio 3
    s_waitcnt lgkmcnt(2)
    v_and_b32 v10, v6, v96
    v_lshlrev_b32 v30, 16, v24
    v_and_b32 v31, v6, v24
    v_lshlrev_b32 v32, 16, v25
    v_and_b32 v33, v6, v25
    v_fma_f32 v30, v30, v10, v5
    v_fma_f32 v31, v31, v10, v5
    v_fma_f32 v32, v32, v10, v5
    v_fma_f32 v33, v33, v10, v5
    v_and_b32 v10, 0xfff8, v96
    v_lshl_add_u64 v[30:31], v[30:31], 0, s[46:47]
    v_add_u32 v10, 40960, v10
    v_lshl_add_u64 v[32:33], v[32:33], 0, s[46:47]
    s_barrier
    s_waitcnt vmcnt(12)
    s_mov_b32 m0, s101
    s_nop 0
    ds_write_addtid_b32 v108 offset:0
    ds_write_addtid_b32 v109 offset:256
    ds_write_addtid_b32 v110 offset:512
    ds_write_addtid_b32 v111 offset:768
    ds_write_addtid_b32 v112 offset:1024
    ds_write_addtid_b32 v113 offset:1280
    ds_write_addtid_b32 v114 offset:1536
    ds_write_addtid_b32 v115 offset:1792
    ds_write_addtid_b32 v116 offset:2048
    ds_write_addtid_b32 v117 offset:2304
    s_setprio 0
    s_cmp_lg_u32 s37, 0
    s_cbranch_scc1 k2_accf_d12
    s_mov_b64 exec, s[56:57]
    ds_add_u64 v10, v[30:31]
    ds_add_u64 v10, v[32:33] offset:50000
    s_mov_b64 exec, -1
    buffer_load_dword v108, v4, s[12:15], 0 offen offset:0
    buffer_load_dword v109, v4, s[12:15], 0 offen offset:256
    buffer_load_dword v110, v4, s[12:15], 0 offen offset:512
    buffer_load_dword v111, v4, s[12:15], 0 offen offset:768
    v_and_b32 v8, v6, v98
    v_lshlrev_b32 v34, 16, v26
    v_and_b32 v35, v6, v26
    v_lshlrev_b32 v36, 16, v27
    v_and_b32 v37, v6, v27
    v_fma_f32 v34, v34, v8, v5
    v_fma_f32 v35, v35, v8, v5
    v_fma_f32 v36, v36, v8, v5
    v_fma_f32 v37, v37, v8, v5
    v_and_b32 v8, 0xfff8, v98
    v_lshl_add_u64 v[34:35], v[34:35], 0, s[46:47]
    v_add_u32 v8, 40960, v8
    v_lshl_add_u64 v[36:37], v[36:37], 0, s[46:47]
k2_acce_d12:
    s_set_gpr_idx_on s35, 0x1
    v_mov_b32 v57, v67
    s_set_gpr_idx_off
    v_cmp_le_u32 s[62:63], v104, v57
    v_cmp_le_u32 s[64:65], v105, v57
    v_cmp_le_u32 s[66:67], v106, v57
    s_waitcnt vmcnt(15)
    v_alignbit_b32 v118, v100, v101, 19
    v_lshlrev_b32 v119, 10, v101
    v_and_b32 v118, 0xfff8, v118
    v_lshlrev_b32 v120, 20, v101
    v_alignbit_b32 v119, v102, v119, 19
    v_alignbit_b32 v120, v103, v120, 19
    v_and_b32 v119, 0xfff8, v119
    v_and_b32 v120, 0xfff8, v120
    s_mov_b64 exec, s[58:59]
    ds_add_u64 v8, v[34:35]
    ds_add_u64 v8, v[36:37] offset:50000
    s_mov_b64 exec, -1
    s_cmp_eq_u64 s[58:59], 0
    s_cbranch_scc1 k2_wz_db12
k2_w_db12:
    s_setprio 3
    s_waitcnt lgkmcnt(4)
    s_barrier
    s_mov_b64 exec, s[62:63]
    ds_read_b64 v[24:25], v118
    s_mov_b64 exec, s[64:65]
    ds_read_b64 v[26:27], v119
    s_mov_b64 exec, s[66:67]
    ds_read_b64 v[50:51], v120
    s_setprio 0
    s_mov_b64 exec, -1
    buffer_load_dword v112, v4, s[12:15], 0 offen offset:1024
    buffer_load_dword v113, v4, s[12:15], 0 offen offset:1280
    buffer_load_dword v114, v4, s[12:15], 0 offen offset:1536
    buffer_load_dword v115, v4, s[12:15], 0 offen offset:1792
    buffer_load_dword v116, v4, s[12:15], 0 offen offset:2048
    buffer_load_dword v117, v4, s[12:15], 0 offen offset:2304
    v_add_u32 v4, 40064, v4
    s_set_gpr_idx_on s35, 0x2
    v_and_b32 v58, 0x7fff0, v69
    v_and_b32 v59, 0x7fff0, v70
    s_set_gpr_idx_off
    v_add_u32 v58, v58, v2
    v_add_u32 v59, v59, v2
    v_and_b32 v9, v6, v99
    v_lshlrev_b32 v38, 16, v28
    v_and_b32 v39, v6, v28
    v_lshlrev_b32 v40, 16, v29
    v_and_b32 v41, v6, v29
    v_fma_f32 v38, v38, v9, v5
    v_fma_f32 v39, v39, v9, v5
    v_fma_f32 v40, v40, v9, v5
    v_fma_f32 v41, v41, v9, v5
    v_and_b32 v9, 0xfff8, v99
    v_lshl_add_u64 v[38:39], v[38:39], 0, s[46:47]
    v_add_u32 v9, 40960, v9
    v_lshl_add_u64 v[40:41], v[40:41], 0, s[46:47]
    s_mov_b64 exec, s[60:61]
    ds_add_u64 v9, v[38:39]
    ds_add_u64 v9, v[40:41] offset:50000
    s_mov_b64 exec, -1
    s_cmp_eq_u64 s[60:61], 0
    s_cbranch_scc1 k2_wz_da13
k2_w_da13:
    s_setprio 3
    s_waitcnt lgkmcnt(2)
    v_and_b32 v10, v6, v100
    v_lshlrev_b32 v30, 16, v24
    v_and_b32 v31, v6, v24
    v_lshlrev_b32 v32, 16, v25
    v_and_b32 v33, v6, v25
    v_fma_f32 v30, v30, v10, v5
    v_fma_f32 v31, v31, v10, v5
    v_fma_f32 v32, v32, v10, v5
    v_fma_f32 v33, v33, v10, v5
    v_and_b32 v10, 0xfff8, v100
    v_lshl_add_u64 v[30:31], v[30:31], 0, s[46:47]
    v_add_u32 v10, 40960, v10
    v_lshl_add_u64 v[32:33], v[32:33], 0, s[46:47]
    s_barrier
    s_waitcnt vmcnt(10)
    buffer_load_dwordx4 v[92:95], v58, s[4:7], 0 offen
    buffer_load_dwordx4 v[96:99], v59, s[4:7], 0 offen
    s_mov_b32 m0, s101
    s_nop 0
    ds_write_addtid_b32 v14 offset:0
    ds_write_addtid_b32 v15 offset:256
    ds_write_addtid_b32 v16 offset:512
    ds_write_addtid_b32 v17 offset:768
    ds_write_addtid_b32 v18 offset:1024
    ds_write_addtid_b32 v19 offset:1280
    ds_write_addtid_b32 v20 offset:1536
    ds_write_addtid_b32 v21 offset:1792
    ds_write_addtid_b32 v22 offset:2048
    ds_write_addtid_b32 v23 offset:2304
    s_setprio 0
    s_cmp_lg_u32 s37, 0
    s_cbranch_scc1 k2_accf_d13
    s_mov_b64 exec, s[62:63]
    ds_add_u64 v10, v[30:31]
    ds_add_u64 v10, v[32:33] offset:50000
    s_mov_b64 exec, -1
    buffer_load_dword v14, v4, s[12:15], 0 offen offset:0
    buffer_load_dword v15, v4, s[12:15], 0 offen offset:256
    buffer_load_dword v16, v4, s[12:15], 0 offen offset:512
    buffer_load_dword v17, v4, s[12:15], 0 offen offset:768
    v_and_b32 v8, v6, v102
    v_lshlrev_b32 v34, 16, v26
    v_and_b32 v35, v6, v26
    v_lshlrev_b32 v36, 16, v27
    v_and_b32 v37, v6, v27
    v_fma_f32 v34, v34, v8, v5
    v_fma_f32 v35, v35, v8, v5
    v_fma_f32 v36, v36, v8, v5
    v_fma_f32 v37, v37, v8, v5
    v_and_b32 v8, 0xfff8, v102
    v_lshl_add_u64 v[34:35], v[34:35], 0, s[46:47]
    v_add_u32 v8, 40960, v8
    v_lshl_add_u64 v[36:37], v[36:37], 0, s[46:47]
k2_acce_d13:
    s_set_gpr_idx_on s35, 0x1
    v_mov_b32 v57, v68
    s_set_gpr_idx_off
    v_cmp_le_u32 s[56:57], v104, v57
    v_cmp_le_u32 s[58:59], v105, v57
    v_cmp_le_u32 s[60:61], v106, v57
    v_alignbit_b32 v118, v88, v89, 19
    v_lshlrev_b32 v119, 10, v89
    v_and_b32 v118, 0xfff8, v118
    v_lshlrev_b32 v120, 20, v89
    v_alignbit_b32 v119, v90, v119, 19
    v_alignbit_b32 v120, v91, v120, 19
    v_and_b32 v119, 0xfff8, v119
    v_and_b32 v120, 0xfff8, v120
    s_add_u32 s35, s35, 4
    s_mov_b64 exec, s[64:65]
    ds_add_u64 v8, v[34:35]
    ds_add_u64 v8, v[36:37] offset:50000
    s_mov_b64 exec, -1
    s_cmp_eq_u64 s[64:65], 0
    s_cbranch_scc1 k2_wz_db13
k2_w_db13:
    s_setprio 3
    s_waitcnt lgkmcnt(4)
    s_barrier
    s_cmp_lt_u32 s35, 20
    s_cbranch_scc1 k2_dloop1
    s_branch k2_dend
k2_dend:
    v_and_b32 v9, v6, v103
    v_lshlrev_b32 v38, 16, v50
    v_and_b32 v39, v6, v50
    v_lshlrev_b32 v40, 16, v51
    v_and_b32 v41, v6, v51
    v_fma_f32 v38, v38, v9, v5
    v_fma_f32 v39, v39, v9, v5
    v_fma_f32 v40, v40, v9, v5
    v_fma_f32 v41, v41, v9, v5
    v_and_b32 v9, 0xfff8, v103
    v_lshl_add_u64 v[38:39], v[38:39], 0, s[46:47]
    v_add_u32 v9, 40960, v9
    v_lshl_add_u64 v[40:41], v[40:41], 0, s[46:47]
    s_mov_b64 exec, s[66:67]
    ds_add_u64 v9, v[38:39]
    ds_add_u64 v9, v[40:41] offset:50000
    s_mov_b64 exec, -1
    s_branch k2_epi
k2_rem:
    s_setprio 1
    s_mov_b32 s94, 0
    v_and_b32 v56, 0x7fff0, v65
    v_and_b32 v58, 0x7fff0, v64
    v_sub_u32 v56, v56, v58
    v_and_b32 v59, 0x7fff3, v64
    v_add_u32 v56, -48, v56
    v_max_i32 v56, 0, v56
    v_mov_b32 v57, v56
    v_add_u32 v59, v59, v2
    v_cmp_ne_u32 s[54:55], 0, v56
    v_add_u32_dpp v57, v57, v57 row_shr:1 row_mask:0xf bank_mask:0xf
    s_nop 1
    v_add_u32_dpp v57, v57, v57 row_shr:2 row_mask:0xf bank_mask:0xf
    s_nop 1
    v_add_u32_dpp v57, v57, v57 row_shr:4 row_mask:0xf bank_mask:0xf
    s_nop 1
    v_add_u32_dpp v57, v57, v57 row_shr:8 row_mask:0xf bank_mask:0xf
    s_nop 1
    v_add_u32_dpp v57, v57, v57 row_bcast:15 row_mask:0xa bank_mask:0xf
    s_nop 1
    v_add_u32_dpp v57, v57, v57 row_bcast:31 row_mask:0xc bank_mask:0xf
    s_nop 1
    v_sub_u32 v58, v57, v56
    v_readlane_b32 s92, v57, 63
    v_sub_u32 v59, v59, v58
    s_add_u32 s40, 0, 1024
    v_cmp_ge_u32 s[48:49], 0, v58
    v_subrev_u32 v60, 0, v58
    v_cmp_eq_u32 s[52:53], s40, v57
    s_bcnt1_i32_b64 s39, s[48:49]
    v_add_u32 v61, -16, v60
    s_sub_u32 s39, s39, 1
    v_cmp_gt_u32 vcc, 1008, v61
    v_readlane_b32 s42, v59, s39
    v_lshrrev_b32 v60, 2, v60
    s_and_b64 s[50:51], vcc, s[54:55]
    v_cndmask_b32 v60, 0, v60, s[50:51]
    v_cndmask_b32 v61, 0, v59, s[50:51]
    ds_permute_b32 v61, v60, v61
    s_waitcnt lgkmcnt(0)
    v_cmp_ne_u32 s[48:49], 0, v61
    v_add_u32 v60, 0, v1
    s_cmp_lg_u64 s[52:53], 0
    v_max_u32_dpp v61, v61, v61 row_shr:1 row_mask:0xf bank_mask:0xf
    v_cmp_gt_u32 s[68:69], s92, v60
    s_cselect_b32 s53, 0x80000000, 0
    v_max_u32_dpp v61, v61, v61 row_shr:2 row_mask:0xf bank_mask:0xf
    s_mov_b32 s52, 0
    s_lshr_b64 s[48:49], s[48:49], 1
    v_max_u32_dpp v61, v61, v61 row_shr:4 row_mask:0xf bank_mask:0xf
    s_or_b64 s[52:53], s[52:53], s[48:49]
    s_lshr_b64 s[48:49], s[68:69], 1
    v_max_u32_dpp v61, v61, v61 row_shr:8 row_mask:0xf bank_mask:0xf
    s_andn2_b64 s[48:49], s[68:69], s[48:49]
    s_bitset0_b64 s[48:49], 63
    v_max_u32_dpp v61, v61, v61 row_bcast:15 row_mask:0xa bank_mask:0xf
    s_or_b64 s[52:53], s[52:53], s[48:49]
    s_nop 0
    v_max_u32_dpp v61, v61, v61 row_bcast:31 row_mask:0xc bank_mask:0xf
    v_max_u32 v61, s42, v61
    v_add_u32 v60, v60, v61
    v_and_b32 v61, 3, v61
    v_and_b32 v60, -16, v60
    v_cmp_eq_u32 s[48:49], 2, v61
    v_cmp_ne_u32 s[50:51], 0, v61
    v_cndmask_b32 v60, v6, v60, s[68:69]
    buffer_load_dwordx4 v[88:91], v60, s[4:7], 0 offen
    s_and_b64 s[48:49], s[48:49], s[52:53]
    s_and_b64 s[50:51], s[50:51], s[52:53]
    s_andn2_b64 s[70:71], s[68:69], s[48:49]
    s_andn2_b64 s[72:73], s[68:69], s[50:51]
    s_cmp_gt_u32 s92, 1024
    s_cbranch_scc1 k2_sy_p0
k2_ns_p0:
    s_waitcnt vmcnt(1)
    s_mov_b32 m0, s101
    s_nop 0
    ds_write_addtid_b32 v14 offset:0
    ds_write_addtid_b32 v15 offset:256
    ds_write_addtid_b32 v16 offset:512
    ds_write_addtid_b32 v17 offset:768
    ds_write_addtid_b32 v18 offset:1024
    ds_write_addtid_b32 v19 offset:1280
    ds_write_addtid_b32 v20 offset:1536
    ds_write_addtid_b32 v21 offset:1792
    ds_write_addtid_b32 v22 offset:2048
    ds_write_addtid_b32 v23 offset:2304
    v_and_b32 v56, 0x7fff0, v84
    v_and_b32 v57, 0x7fff0, v64
    v_sub_u32 v56, v56, v57
    s_lshl_b32 s39, s32, 2
    s_add_u32 s39, s39, 140960
    v_add_u32_dpp v56, v56, v56 row_shr:1 row_mask:0xf bank_mask:0xf
    s_nop 1
    v_add_u32_dpp v56, v56, v56 row_shr:2 row_mask:0xf bank_mask:0xf
    s_nop 1
    v_add_u32_dpp v56, v56, v56 row_shr:4 row_mask:0xf bank_mask:0xf
    s_nop 1
    v_add_u32_dpp v56, v56, v56 row_shr:8 row_mask:0xf bank_mask:0xf
    s_nop 1
    v_add_u32_dpp v56, v56, v56 row_bcast:15 row_mask:0xa bank_mask:0xf
    s_nop 1
    v_add_u32_dpp v56, v56, v56 row_bcast:31 row_mask:0xc bank_mask:0xf
    s_nop 1
    v_mov_b32 v59, s39
    s_mov_b32 exec_lo, 0
    s_mov_b32 exec_hi, 0x80000000
    ds_write_b32 v59, v56
    s_mov_b64 exec, -1
    s_waitcnt lgkmcnt(0)
    s_barrier
    v_add_u32 v42, 40960, v3
    ds_write_b128 v42, v[30:33]
    ds_write_b128 v42, v[30:33] offset:16384
    v_mov_b32 v42, 140960
    ds_read_b128 v[42:45], v42
    s_mov_b32 s41, s31
    s_waitcnt lgkmcnt(0)
    v_add_u32 v42, v42, v43
    v_add_u32 v44, v44, v45
    v_add_u32 v42, v42, v44
    v_lshrrev_b32 v42, 4, v42
    v_mul_u32_u24 v42, 3, v42
    v_max_u32 v42, 1024, v42
    s_nop 0
    v_readfirstlane_b32 s39, v42
    v_cvt_f32_u32 v42, v42
    v_mul_f32 v42, s41, v42
    v_mul_f32 v42, 0x3f802000, v42
    s_nop 0
    v_readfirstlane_b32 s40, v42
    s_mov_b32 s37, 0
    s_cmp_gt_u32 s39, 0x100000
    s_cselect_b32 s37, 1, s37
    s_cmp_gt_u32 s41, 0x70000000
    s_cselect_b32 s37, 1, s37
    s_cmp_lt_u32 s41, 0x18000000
    s_cselect_b32 s37, 1, s37
    s_and_b32 s40, s40, 0x7f800000
    s_cmp_gt_u32 s40, s30
    s_cselect_b32 s37, 1, s37
    s_and_b32 s41, s41, 0x7f800000
    s_sub_u32 s38, s40, s41
    s_add_u32 s3, s41, 50331648
    s_add_u32 s38, s38, 763363328
    s_sub_u32 s40, s40, 54525952
    v_mov_b32 v5, s40
    s_sub_u32 s46, 0, s40
    s_not_b32 s47, s40
    s_barrier
    v_and_b32 v56, 0x7fff0, v66
    v_and_b32 v58, 0x7fff0, v65
    v_sub_u32 v56, v56, v58
    v_and_b32 v59, 0x7fff3, v65
    v_add_u32 v56, -48, v56
    v_max_i32 v56, 0, v56
    v_mov_b32 v57, v56
    v_add_u32 v59, v59, v2
    v_cmp_ne_u32 s[54:55], 0, v56
    v_add_u32_dpp v57, v57, v57 row_shr:1 row_mask:0xf bank_mask:0xf
    s_nop 1
    v_add_u32_dpp v57, v57, v57 row_shr:2 row_mask:0xf bank_mask:0xf
    s_nop 1
    v_add_u32_dpp v57, v57, v57 row_shr:4 row_mask:0xf bank_mask:0xf
    s_nop 1
    v_add_u32_dpp v57, v57, v57 row_shr:8 row_mask:0xf bank_mask:0xf
    s_nop 1
    v_add_u32_dpp v57, v57, v57 row_bcast:15 row_mask:0xa bank_mask:0xf
    s_nop 1
    v_add_u32_dpp v57, v57, v57 row_bcast:31 row_mask:0xc bank_mask:0xf
    s_nop 1
    v_sub_u32 v58, v57, v56
    v_readlane_b32 s93, v57, 63
    v_sub_u32 v59, v59, v58
    s_add_u32 s40, 0, 1024
    v_cmp_ge_u32 s[48:49], 0, v58
    v_subrev_u32 v60, 0, v58
    v_cmp_eq_u32 s[52:53], s40, v57
    s_bcnt1_i32_b64 s39, s[48:49]
    v_add_u32 v61, -16, v60
    s_sub_u32 s39, s39, 1
    v_cmp_gt_u32 vcc, 1008, v61
    v_readlane_b32 s42, v59, s39
    v_lshrrev_b32 v60, 2, v60
    s_and_b64 s[50:51], vcc, s[54:55]
    v_cndmask_b32 v60, 0, v60, s[50:51]
    v_cndmask_b32 v61, 0, v59, s[50:51]
    ds_permute_b32 v61, v60, v61
    buffer_load_dword v108, v4, s[12:15], 0 offen offset:0
    buffer_load_dword v109, v4, s[12:15], 0 offen offset:256
    buffer_load_dword v110, v4, s[12:15], 0 offen offset:512
    buffer_load_dword v111, v4, s[12:15], 0 offen offset:768
    buffer_load_dword v112, v4, s[12:15], 0 offen offset:1024
    buffer_load_dword v113, v4, s[12:15], 0 offen offset:1280
    buffer_load_dword v114, v4, s[12:15], 0 offen offset:1536
    buffer_load_dword v115, v4, s[12:15], 0 offen offset:1792
    buffer_load_dword v116, v4, s[12:15], 0 offen offset:2048
    buffer_load_dword v117, v4, s[12:15], 0 offen offset:2304
    v_add_u32 v4, 40064, v4
    buffer_load_dword v14, v4, s[12:15], 0 offen offset:0
    buffer_load_dword v15, v4, s[12:15], 0 offen offset:256
    buffer_load_dword v16, v4, s[12:15], 0 offen offset:512
    buffer_load_dword v17, v4, s[12:15], 0 offen offset:768
    s_waitcnt lgkmcnt(0)
    v_cmp_ne_u32 s[48:49], 0, v61
    v_add_u32 v60, 0, v1
    s_cmp_lg_u64 s[52:53], 0
    v_max_u32_dpp v61, v61, v61 row_shr:1 row_mask:0xf bank_mask:0xf
    v_cmp_gt_u32 s[74:75], s93, v60
    s_cselect_b32 s53, 0x80000000, 0
    v_max_u32_dpp v61, v61, v61 row_shr:2 row_mask:0xf bank_mask:0xf
    s_mov_b32 s52, 0
    s_lshr_b64 s[48:49], s[48:49], 1
    v_max_u32_dpp v61, v61, v61 row_shr:4 row_mask:0xf bank_mask:0xf
    s_or_b64 s[52:53], s[52:53], s[48:49]
    s_lshr_b64 s[48:49], s[74:75], 1
    v_max_u32_dpp v61, v61, v61 row_shr:8 row_mask:0xf bank_mask:0xf
    s_andn2_b64 s[48:49], s[74:75], s[48:49]
    s_bitset0_b64 s[48:49], 63
    v_max_u32_dpp v61, v61, v61 row_bcast:15 row_mask:0xa bank_mask:0xf
    s_or_b64 s[52:53], s[52:53], s[48:49]
    s_nop 0
    v_max_u32_dpp v61, v61, v61 row_bcast:31 row_mask:0xc bank_mask:0xf
    v_max_u32 v61, s42, v61
    v_add_u32 v60, v60, v61
    v_and_b32 v61, 3, v61
    v_and_b32 v60, -16, v60
    v_cmp_eq_u32 s[48:49], 2, v61
    v_cmp_ne_u32 s[50:51], 0, v61
    v_cndmask_b32 v60, v6, v60, s[74:75]
    buffer_load_dwordx4 v[92:95], v60, s[4:7], 0 offen
    s_and_b64 s[48:49], s[48:49], s[52:53]
    s_and_b64 s[50:51], s[50:51], s[52:53]
    s_andn2_b64 s[76:77], s[74:75], s[48:49]
    s_andn2_b64 s[78:79], s[74:75], s[50:51]
    s_cmp_gt_u32 s93, 1024
    s_cbranch_scc1 k2_sy_p1
k2_ns_p1:
    s_set_gpr_idx_on s35, 0x1
    v_mov_b32 v62, v66
    v_mov_b32 v63, v67
    s_set_gpr_idx_off
    v_and_b32 v56, 0x7fff0, v63
    v_and_b32 v58, 0x7fff0, v62
    v_sub_u32 v56, v56, v58
    v_and_b32 v59, 0x7fff3, v62
    v_add_u32 v56, -48, v56
    v_max_i32 v56, 0, v56
    v_mov_b32 v57, v56
    v_add_u32 v59, v59, v2
    v_cmp_ne_u32 s[54:55], 0, v56
    v_add_u32_dpp v57, v57, v57 row_shr:1 row_mask:0xf bank_mask:0xf
    s_nop 1
    v_add_u32_dpp v57, v57, v57 row_shr:2 row_mask:0xf bank_mask:0xf
    s_nop 1
    v_add_u32_dpp v57, v57, v57 row_shr:4 row_mask:0xf bank_mask:0xf
    s_nop 1
    v_add_u32_dpp v57, v57, v57 row_shr:8 row_mask:0xf bank_mask:0xf
    s_nop 1
    v_add_u32_dpp v57, v57, v57 row_bcast:15 row_mask:0xa bank_mask:0xf
    s_nop 1
    v_add_u32_dpp v57, v57, v57 row_bcast:31 row_mask:0xc bank_mask:0xf
    s_nop 1
    v_sub_u32 v58, v57, v56
    v_readlane_b32 s100, v57, 63
    v_sub_u32 v59, v59, v58
    s_waitcnt vmcnt(15)
    s_mov_b64 s[56:57], s[68:69]
    s_mov_b64 s[58:59], s[70:71]
    s_mov_b64 s[60:61], s[72:73]
    v_alignbit_b32 v118, v88, v89, 19
    v_lshlrev_b32 v119, 10, v89
    v_and_b32 v118, 0xfff8, v118
    v_lshlrev_b32 v120, 20, v89
    v_alignbit_b32 v119, v90, v119, 19
    v_alignbit_b32 v120, v91, v120, 19
    v_and_b32 v119, 0xfff8, v119
    v_and_b32 v120, 0xfff8, v120
k2_rloop:
    s_mov_b64 exec, s[56:57]
    ds_read_b64 v[24:25], v118
    s_mov_b64 exec, s[58:59]
    ds_read_b64 v[26:27], v119
    s_mov_b64 exec, s[60:61]
    ds_read_b64 v[28:29], v120
    s_mov_b64 exec, -1
    s_cmp_gt_u32 s92, 1024
    s_cbranch_scc1 k2_xy_0
k2_nx_0:
    s_add_u32 s40, 0, 1024
    v_cmp_ge_u32 s[48:49], 0, v58
    v_subrev_u32 v60, 0, v58
    v_cmp_eq_u32 s[52:53], s40, v57
    s_bcnt1_i32_b64 s39, s[48:49]
    v_add_u32 v61, -16, v60
    s_sub_u32 s39, s39, 1
    v_cmp_gt_u32 vcc, 1008, v61
    v_readlane_b32 s42, v59, s39
    v_lshrrev_b32 v60, 2, v60
    s_and_b64 s[50:51], vcc, s[54:55]
    v_cndmask_b32 v60, 0, v60, s[50:51]
    v_cndmask_b32 v61, 0, v59, s[50:51]
    ds_permute_b32 v61, v60, v61
    s_setprio 1
    buffer_load_dword v18, v4, s[12:15], 0 offen offset:1024
    buffer_load_dword v19, v4, s[12:15], 0 offen offset:1280
    buffer_load_dword v20, v4, s[12:15], 0 offen offset:1536
    buffer_load_dword v21, v4, s[12:15], 0 offen offset:1792
    buffer_load_dword v22, v4, s[12:15], 0 offen offset:2048
    buffer_load_dword v23, v4, s[12:15], 0 offen offset:2304
    v_add_u32 v4, 40064, v4
    s_mov_b32 s92, s100
    v_and_b32 v9, v6, v106
    v_lshlrev_b32 v38, 16, v104
    v_and_b32 v39, v6, v104
    v_lshlrev_b32 v40, 16, v105
    v_and_b32 v41, v6, v105
    v_fma_f32 v38, v38, v9, v5
    v_fma_f32 v39, v39, v9, v5
    v_fma_f32 v40, v40, v9, v5
    v_fma_f32 v41, v41, v9, v5
    v_and_b32 v9, 0xfff8, v106
    v_lshl_add_u64 v[38:39], v[38:39], 0, s[46:47]
    v_add_u32 v9, 40960, v9
    v_lshl_add_u64 v[40:41], v[40:41], 0, s[46:47]
    s_mov_b64 exec, s[66:67]
    ds_add_u64 v9, v[38:39]
    ds_add_u64 v9, v[40:41] offset:50000
    s_mov_b64 exec, -1
    s_cmp_eq_u64 s[66:67], 0
    s_cbranch_scc1 k2_wz_ra0
k2_w_ra0:
    s_setprio 3
    s_waitcnt lgkmcnt(2)
    s_barrier
    s_waitcnt vmcnt(11)
    s_mov_b32 m0, s101
    s_nop 0
    ds_write_addtid_b32 v108 offset:0
    ds_write_addtid_b32 v109 offset:256
    ds_write_addtid_b32 v110 offset:512
    ds_write_addtid_b32 v111 offset:768
    ds_write_addtid_b32 v112 offset:1024
    ds_write_addtid_b32 v113 offset:1280
    ds_write_addtid_b32 v114 offset:1536
    ds_write_addtid_b32 v115 offset:1792
    ds_write_addtid_b32 v116 offset:2048
    ds_write_addtid_b32 v117 offset:2304
    s_setprio 1
    s_cmp_lg_u32 s37, 0
    s_cbranch_scc1 k2_accf_r0
    v_and_b32 v10, v6, v88
    v_lshlrev_b32 v30, 16, v24
    v_and_b32 v31, v6, v24
    v_lshlrev_b32 v32, 16, v25
    v_and_b32 v33, v6, v25
    v_fma_f32 v30, v30, v10, v5
    v_fma_f32 v31, v31, v10, v5
    v_fma_f32 v32, v32, v10, v5
    v_fma_f32 v33, v33, v10, v5
    v_and_b32 v10, 0xfff8, v88
    v_lshl_add_u64 v[30:31], v[30:31], 0, s[46:47]
    v_add_u32 v10, 40960, v10
    v_lshl_add_u64 v[32:33], v[32:33], 0, s[46:47]
    s_mov_b64 exec, s[56:57]
    ds_add_u64 v10, v[30:31]
    ds_add_u64 v10, v[32:33] offset:50000
    s_mov_b64 exec, -1
    buffer_load_dword v108, v4, s[12:15], 0 offen offset:0
    buffer_load_dword v109, v4, s[12:15], 0 offen offset:256
    buffer_load_dword v110, v4, s[12:15], 0 offen offset:512
    buffer_load_dword v111, v4, s[12:15], 0 offen offset:768
    v_and_b32 v8, v6, v90
    v_lshlrev_b32 v34, 16, v26
    v_and_b32 v35, v6, v26
    v_lshlrev_b32 v36, 16, v27
    v_and_b32 v37, v6, v27
    v_fma_f32 v34, v34, v8, v5
    v_fma_f32 v35, v35, v8, v5
    v_fma_f32 v36, v36, v8, v5
    v_fma_f32 v37, v37, v8, v5
    v_and_b32 v8, 0xfff8, v90
    v_lshl_add_u64 v[34:35], v[34:35], 0, s[46:47]
    v_add_u32 v8, 40960, v8
    v_lshl_add_u64 v[36:37], v[36:37], 0, s[46:47]
k2_acce_r0:
    v_mov_b32 v106, v91
    s_cmp_lg_u32 s94, 0
    s_cbranch_scc1 k2_xb_0
k2_xe_0:
    v_cmp_ne_u32 s[48:49], 0, v61
    v_add_u32 v60, 0, v1
    s_cmp_lg_u64 s[52:53], 0
    v_max_u32_dpp v61, v61, v61 row_shr:1 row_mask:0xf bank_mask:0xf
    v_cmp_gt_u32 s[68:69], s92, v60
    s_cselect_b32 s53, 0x80000000, 0
    v_max_u32_dpp v61, v61, v61 row_shr:2 row_mask:0xf bank_mask:0xf
    s_mov_b32 s52, 0
    s_lshr_b64 s[48:49], s[48:49], 1
    v_max_u32_dpp v61, v61, v61 row_shr:4 row_mask:0xf bank_mask:0xf
    s_or_b64 s[52:53], s[52:53], s[48:49]
    s_lshr_b64 s[48:49], s[68:69], 1
    v_max_u32_dpp v61, v61, v61 row_shr:8 row_mask:0xf bank_mask:0xf
    s_andn2_b64 s[48:49], s[68:69], s[48:49]
    s_bitset0_b64 s[48:49], 63
    v_max_u32_dpp v61, v61, v61 row_bcast:15 row_mask:0xa bank_mask:0xf
    s_or_b64 s[52:53], s[52:53], s[48:49]
    s_nop 0
    v_max_u32_dpp v61, v61, v61 row_bcast:31 row_mask:0xc bank_mask:0xf
    v_max_u32 v61, s42, v61
    v_add_u32 v60, v60, v61
    v_and_b32 v61, 3, v61
    v_and_b32 v60, -16, v60
    v_cmp_eq_u32 s[48:49], 2, v61
    v_cmp_ne_u32 s[50:51], 0, v61
    v_cndmask_b32 v60, v6, v60, s[68:69]
    buffer_load_dwordx4 v[88:91], v60, s[4:7], 0 offen
    s_and_b64 s[48:49], s[48:49], s[52:53]
    s_and_b64 s[50:51], s[50:51], s[52:53]
    s_andn2_b64 s[70:71], s[68:69], s[48:49]
    s_andn2_b64 s[72:73], s[68:69], s[50:51]
    s_cmp_gt_u32 s92, 1024
    s_cbranch_scc1 k2_sy_l0
k2_ns_l0:
    s_set_gpr_idx_on s35, 0x1
    v_mov_b32 v62, v67
    v_mov_b32 v63, v68
    s_set_gpr_idx_off
    v_and_b32 v56, 0x7fff0, v63
    v_and_b32 v58, 0x7fff0, v62
    v_sub_u32 v56, v56, v58
    v_and_b32 v59, 0x7fff3, v62
    v_add_u32 v56, -48, v56
    v_max_i32 v56, 0, v56
    v_mov_b32 v57, v56
    v_add_u32 v59, v59, v2
    v_cmp_ne_u32 s[54:55], 0, v56
    v_add_u32_dpp v57, v57, v57 row_shr:1 row_mask:0xf bank_mask:0xf
    s_nop 1
    v_add_u32_dpp v57, v57, v57 row_shr:2 row_mask:0xf bank_mask:0xf
    s_nop 1
    v_add_u32_dpp v57, v57, v57 row_shr:4 row_mask:0xf bank_mask:0xf
    s_nop 1
    v_add_u32_dpp v57, v57, v57 row_shr:8 row_mask:0xf bank_mask:0xf
    s_nop 1
    v_add_u32_dpp v57, v57, v57 row_bcast:15 row_mask:0xa bank_mask:0xf
    s_nop 1
    v_add_u32_dpp v57, v57, v57 row_bcast:31 row_mask:0xc bank_mask:0xf
    s_nop 1
    v_sub_u32 v58, v57, v56
    v_readlane_b32 s100, v57, 63
    v_sub_u32 v59, v59, v58
    s_waitcnt vmcnt(11)
    s_mov_b64 s[62:63], s[74:75]
    s_mov_b64 s[64:65], s[76:77]
    s_mov_b64 s[66:67], s[78:79]
    v_alignbit_b32 v118, v92, v93, 19
    v_lshlrev_b32 v119, 10, v93
    v_and_b32 v118, 0xfff8, v118
    v_lshlrev_b32 v120, 20, v93
    v_alignbit_b32 v119, v94, v119, 19
    v_alignbit_b32 v120, v95, v120, 19
    v_and_b32 v119, 0xfff8, v119
    v_and_b32 v120, 0xfff8, v120
    s_mov_b64 exec, s[58:59]
    ds_add_u64 v8, v[34:35]
    ds_add_u64 v8, v[36:37] offset:50000
    s_mov_b64 exec, -1
    s_cmp_eq_u64 s[58:59], 0
    s_cbranch_scc1 k2_wz_rb0
k2_w_rb0:
    s_setprio 3
    s_waitcnt lgkmcnt(4)
    s_barrier
    s_mov_b64 exec, s[62:63]
    ds_read_b64 v[24:25], v118
    s_mov_b64 exec, s[64:65]
    ds_read_b64 v[26:27], v119
    s_mov_b64 exec, s[66:67]
    ds_read_b64 v[104:105], v120
    s_mov_b64 exec, -1
    s_cmp_gt_u32 s93, 1024
    s_cbranch_scc1 k2_xy_1
k2_nx_1:
    s_add_u32 s40, 0, 1024
    v_cmp_ge_u32 s[48:49], 0, v58
    v_subrev_u32 v60, 0, v58
    v_cmp_eq_u32 s[52:53], s40, v57
    s_bcnt1_i32_b64 s39, s[48:49]
    v_add_u32 v61, -16, v60
    s_sub_u32 s39, s39, 1
    v_cmp_gt_u32 vcc, 1008, v61
    v_readlane_b32 s42, v59, s39
    v_lshrrev_b32 v60, 2, v60
    s_and_b64 s[50:51], vcc, s[54:55]
    v_cndmask_b32 v60, 0, v60, s[50:51]
    v_cndmask_b32 v61, 0, v59, s[50:51]
    ds_permute_b32 v61, v60, v61
    s_setprio 1
    buffer_load_dword v112, v4, s[12:15], 0 offen offset:1024
    buffer_load_dword v113, v4, s[12:15], 0 offen offset:1280
    buffer_load_dword v114, v4, s[12:15], 0 offen offset:1536
    buffer_load_dword v115, v4, s[12:15], 0 offen offset:1792
    buffer_load_dword v116, v4, s[12:15], 0 offen offset:2048
    buffer_load_dword v117, v4, s[12:15], 0 offen offset:2304
    v_add_u32 v4, 40064, v4
    s_mov_b32 s93, s100
    v_and_b32 v9, v6, v106
    v_lshlrev_b32 v38, 16, v28
    v_and_b32 v39, v6, v28
    v_lshlrev_b32 v40, 16, v29
    v_and_b32 v41, v6, v29
    v_fma_f32 v38, v38, v9, v5
    v_fma_f32 v39, v39, v9, v5
    v_fma_f32 v40, v40, v9, v5
    v_fma_f32 v41, v41, v9, v5
    v_and_b32 v9, 0xfff8, v106
    v_lshl_add_u64 v[38:39], v[38:39], 0, s[46:47]
    v_add_u32 v9, 40960, v9
    v_lshl_add_u64 v[40:41], v[40:41], 0, s[46:47]
    s_mov_b64 exec, s[60:61]
    ds_add_u64 v9, v[38:39]
    ds_add_u64 v9, v[40:41] offset:50000
    s_mov_b64 exec, -1
    s_cmp_eq_u64 s[60:61], 0
    s_cbranch_scc1 k2_wz_ra1
k2_w_ra1:
    s_setprio 3
    s_waitcnt lgkmcnt(2)
    s_barrier
    s_waitcnt vmcnt(11)
    s_mov_b32 m0, s101
    s_nop 0
    ds_write_addtid_b32 v14 offset:0
    ds_write_addtid_b32 v15 offset:256
    ds_write_addtid_b32 v16 offset:512
    ds_write_addtid_b32 v17 offset:768
    ds_write_addtid_b32 v18 offset:1024
    ds_write_addtid_b32 v19 offset:1280
    ds_write_addtid_b32 v20 offset:1536
    ds_write_addtid_b32 v21 offset:1792
    ds_write_addtid_b32 v22 offset:2048
    ds_write_addtid_b32 v23 offset:2304
    s_setprio 1
    s_cmp_lg_u32 s37, 0
    s_cbranch_scc1 k2_accf_r1
    v_and_b32 v10, v6, v92
    v_lshlrev_b32 v30, 16, v24
    v_and_b32 v31, v6, v24
    v_lshlrev_b32 v32, 16, v25
    v_and_b32 v33, v6, v25
    v_fma_f32 v30, v30, v10, v5
    v_fma_f32 v31, v31, v10, v5
    v_fma_f32 v32, v32, v10, v5
    v_fma_f32 v33, v33, v10, v5
    v_and_b32 v10, 0xfff8, v92
    v_lshl_add_u64 v[30:31], v[30:31], 0, s[46:47]
    v_add_u32 v10, 40960, v10
    v_lshl_add_u64 v[32:33], v[32:33], 0, s[46:47]
    s_mov_b64 exec, s[62:63]
    ds_add_u64 v10, v[30:31]
    ds_add_u64 v10, v[32:33] offset:50000
    s_mov_b64 exec, -1
    buffer_load_dword v14, v4, s[12:15], 0 offen offset:0
    buffer_load_dword v15, v4, s[12:15], 0 offen offset:256
    buffer_load_dword v16, v4, s[12:15], 0 offen offset:512
    buffer_load_dword v17, v4, s[12:15], 0 offen offset:768
    v_and_b32 v8, v6, v94
    v_lshlrev_b32 v34, 16, v26
    v_and_b32 v35, v6, v26
    v_lshlrev_b32 v36, 16, v27
    v_and_b32 v37, v6, v27
    v_fma_f32 v34, v34, v8, v5
    v_fma_f32 v35, v35, v8, v5
    v_fma_f32 v36, v36, v8, v5
    v_fma_f32 v37, v37, v8, v5
    v_and_b32 v8, 0xfff8, v94
    v_lshl_add_u64 v[34:35], v[34:35], 0, s[46:47]
    v_add_u32 v8, 40960, v8
    v_lshl_add_u64 v[36:37], v[36:37], 0, s[46:47]
k2_acce_r1:
    v_mov_b32 v106, v95
    s_cmp_eq_u32 s35, 16
    s_cbranch_scc1 k2_ey_r
k2_en_r:
    s_cmp_lg_u32 s94, 0
    s_cbranch_scc1 k2_xb_1
k2_xe_1:
    v_cmp_ne_u32 s[48:49], 0, v61
    v_add_u32 v60, 0, v1
    s_cmp_lg_u64 s[52:53], 0
    v_max_u32_dpp v61, v61, v61 row_shr:1 row_mask:0xf bank_mask:0xf
    v_cmp_gt_u32 s[74:75], s93, v60
    s_cselect_b32 s53, 0x80000000, 0
    v_max_u32_dpp v61, v61, v61 row_shr:2 row_mask:0xf bank_mask:0xf
    s_mov_b32 s52, 0
    s_lshr_b64 s[48:49], s[48:49], 1
    v_max_u32_dpp v61, v61, v61 row_shr:4 row_mask:0xf bank_mask:0xf
    s_or_b64 s[52:53], s[52:53], s[48:49]
    s_lshr_b64 s[48:49], s[74:75], 1
    v_max_u32_dpp v61, v61, v61 row_shr:8 row_mask:0xf bank_mask:0xf
    s_andn2_b64 s[48:49], s[74:75], s[48:49]
    s_bitset0_b64 s[48:49], 63
    v_max_u32_dpp v61, v61, v61 row_bcast:15 row_mask:0xa bank_mask:0xf
    s_or_b64 s[52:53], s[52:53], s[48:49]
    s_nop 0
    v_max_u32_dpp v61, v61, v61 row_bcast:31 row_mask:0xc bank_mask:0xf
    v_max_u32 v61, s42, v61
    v_add_u32 v60, v60, v61
    v_and_b32 v61, 3, v61
    v_and_b32 v60, -16, v60
    v_cmp_eq_u32 s[48:49], 2, v61
    v_cmp_ne_u32 s[50:51], 0, v61
    v_cndmask_b32 v60, v6, v60, s[74:75]
    buffer_load_dwordx4 v[92:95], v60, s[4:7], 0 offen
    s_and_b64 s[48:49], s[48:49], s[52:53]
    s_and_b64 s[50:51], s[50:51], s[52:53]
    s_andn2_b64 s[76:77], s[74:75], s[48:49]
    s_andn2_b64 s[78:79], s[74:75], s[50:51]
    s_cmp_gt_u32 s93, 1024
    s_cbranch_scc1 k2_sy_l1
k2_ns_l1:
    s_set_gpr_idx_on s35, 0x1
    v_mov_b32 v62, v68
    v_mov_b32 v63, v69
    s_set_gpr_idx_off
    v_and_b32 v56, 0x7fff0, v63
    v_and_b32 v58, 0x7fff0, v62
    v_sub_u32 v56, v56, v58
    v_and_b32 v59, 0x7fff3, v62
    v_add_u32 v56, -48, v56
    v_max_i32 v56, 0, v56
    v_mov_b32 v57, v56
    v_add_u32 v59, v59, v2
    v_cmp_ne_u32 s[54:55], 0, v56
    v_add_u32_dpp v57, v57, v57 row_shr:1 row_mask:0xf bank_mask:0xf
    s_nop 1
    v_add_u32_dpp v57, v57, v57 row_shr:2 row_mask:0xf bank_mask:0xf
    s_nop 1
    v_add_u32_dpp v57, v57, v57 row_shr:4 row_mask:0xf bank_mask:0xf
    s_nop 1
    v_add_u32_dpp v57, v57, v57 row_shr:8 row_mask:0xf bank_mask:0xf
    s_nop 1
    v_add_u32_dpp v57, v57, v57 row_bcast:15 row_mask:0xa bank_mask:0xf
    s_nop 1
    v_add_u32_dpp v57, v57, v57 row_bcast:31 row_mask:0xc bank_mask:0xf
    s_nop 1
    v_sub_u32 v58, v57, v56
    v_readlane_b32 s100, v57, 63
    v_sub_u32 v59, v59, v58
    s_waitcnt vmcnt(11)
    s_mov_b64 s[56:57], s[68:69]
    s_mov_b64 s[58:59], s[70:71]
    s_mov_b64 s[60:61], s[72:73]
    v_alignbit_b32 v118, v88, v89, 19
    v_lshlrev_b32 v119, 10, v89
    v_and_b32 v118, 0xfff8, v118
    v_lshlrev_b32 v120, 20, v89
    v_alignbit_b32 v119, v90, v119, 19
    v_alignbit_b32 v120, v91, v120, 19
    v_and_b32 v119, 0xfff8, v119
    v_and_b32 v120, 0xfff8, v120
    s_mov_b64 exec, s[64:65]
    ds_add_u64 v8, v[34:35]
    ds_add_u64 v8, v[36:37] offset:50000
    s_mov_b64 exec, -1
    s_add_u32 s35, s35, 2
    s_cmp_eq_u64 s[64:65], 0
    s_cbranch_scc1 k2_wz_rb1
k2_w_rb1:
    s_setprio 3
    s_waitcnt lgkmcnt(4)
    s_barrier
    s_cmp_lt_u32 s35, 20
    s_cbranch_scc1 k2_rloop
k2_rend:
    v_and_b32 v9, v6, v106
    v_lshlrev_b32 v38, 16, v104
    v_and_b32 v39, v6, v104
    v_lshlrev_b32 v40, 16, v105
    v_and_b32 v41, v6, v105
    v_fma_f32 v38, v38, v9, v5
    v_fma_f32 v39, v39, v9, v5
    v_fma_f32 v40, v40, v9, v5
    v_fma_f32 v41, v41, v9, v5
    v_and_b32 v9, 0xfff8, v106
    v_lshl_add_u64 v[38:39], v[38:39], 0, s[46:47]
    v_add_u32 v9, 40960, v9
    v_lshl_add_u64 v[40:41], v[40:41], 0, s[46:47]
    s_mov_b64 exec, s[66:67]
    ds_add_u64 v9, v[38:39]
    ds_add_u64 v9, v[40:41] offset:50000
    s_mov_b64 exec, -1
k2_epi:
    s_load_dwordx2 s[8:9], s[0:1], 88
    s_load_dwordx2 s[20:21], s[0:1], 40
    s_load_dwordx4 s[88:91], s[0:1], 56
    s_load_dwordx4 s[92:95], s[0:1], 72
    v_mov_b32 v5, s38
    s_mul_i32 s39, s34, 3200000
    s_mul_i32 s40, s33, 50000
    s_add_u32 s39, s39, s40
    v_cmp_ne_u32 s[46:47], v121, v6
    s_mov_b32 s35, s39
    s_add_u32 s16, s22, s39
    s_addc_u32 s17, s23, 0
    s_add_u32 s16, s16, 90177536
    s_addc_u32 s17, s17, 0
    s_mov_b32 s18, 50000
    s_mov_b32 s19, 0x00020000
    s_add_u32 s24, s22, 89210880
    s_addc_u32 s25, s23, 0
    s_mov_b32 s26, 8192
    s_mov_b32 s27, 0x00020000
    v_min_u32 v4, 12496, v3
    s_add_u32 s39, s34, 1
    s_and_b32 s39, s39, 3
    s_mul_i32 s39, s39, 12512
    v_add_u32 v42, s39, v4
    v_min_u32 v42, 49984, v42
    v_add_u32 v46, 40960, v42
    s_add_u32 s39, s34, 2
    s_and_b32 s39, s39, 3
    s_mul_i32 s39, s39, 12512
    v_add_u32 v43, s39, v4
    v_min_u32 v43, 49984, v43
    v_add_u32 v47, 40960, v43
    s_add_u32 s39, s34, 3
    s_and_b32 s39, s39, 3
    s_mul_i32 s39, s39, 12512
    v_add_u32 v44, s39, v4
    v_min_u32 v44, 49984, v44
    v_add_u32 v48, 40960, v44
    s_add_u32 s39, s34, 4
    s_and_b32 s39, s39, 3
    s_mul_i32 s39, s39, 12512
    v_add_u32 v45, s39, v4
    v_min_u32 v45, 49984, v45
    v_add_u32 v49, 40960, v45
    s_waitcnt vmcnt(0) lgkmcnt(0)
    s_load_dwordx4 s[28:31], s[20:21], 0
    s_load_dwordx16 s[48:63], s[88:89], 0
    s_load_dwordx16 s[64:79], s[90:91], 0
    s_mov_b64 s[20:21], s[92:93]
    s_mov_b64 s[42:43], s[94:95]
    s_cmp_gt_u32 s32, 12
    s_barrier
    s_cbranch_scc1 k2_sig
    ds_read_b128 v[64:67], v46
    ds_read_b128 v[68:71], v46 offset:50000
    ds_read_b128 v[72:75], v47
    ds_read_b128 v[76:79], v47 offset:50000
    ds_read_b128 v[80:83], v48
    ds_read_b128 v[84:87], v48 offset:50000
    ds_read_b128 v[88:91], v49
    ds_read_b128 v[92:95], v49 offset:50000
    s_mov_b32 s10, 3200000
    s_mov_b32 s11, 0x00020000
    s_add_u32 s39, s38, s3
    s_sub_u32 s39, s39, 1065353216
    v_mov_b32 v2, s39
    s_cmp_lg_u32 s37, 0
    s_waitcnt lgkmcnt(0)
    s_cbranch_scc1 k2_epf
    v_ashrrev_i32 v58, 31, v64
    v_ashrrev_i32 v59, 31, v66
    v_ashrrev_i32 v60, 31, v68
    v_ashrrev_i32 v61, 31, v70
    v_sub_u32 v65, v65, v58
    v_sub_u32 v67, v67, v59
    v_sub_u32 v69, v69, v60
    v_sub_u32 v71, v71, v61
    v_cvt_f32_i32 v64, v64
    v_cvt_f32_i32 v65, v65
    v_cvt_f32_i32 v66, v66
    v_cvt_f32_i32 v67, v67
    v_cvt_f32_i32 v68, v68
    v_cvt_f32_i32 v69, v69
    v_cvt_f32_i32 v70, v70
    v_cvt_f32_i32 v71, v71
    v_mul_f32 v64, v5, v64
    v_mul_f32 v65, v5, v65
    v_mul_f32 v66, v5, v66
    v_mul_f32 v67, v5, v67
    v_mul_f32 v68, v5, v68
    v_mul_f32 v69, v5, v69
    v_mul_f32 v70, v5, v70
    v_mul_f32 v71, v5, v71
    v_cvt_pk_f16_f32 v64, v64, v65
    v_cvt_pk_f16_f32 v65, v68, v69
    v_cvt_pk_f16_f32 v66, v66, v67
    v_cvt_pk_f16_f32 v67, v70, v71
    buffer_store_dwordx4 v[64:67], v42, s[16:19], 0 offen sc1
    v_ashrrev_i32 v58, 31, v72
    v_ashrrev_i32 v59, 31, v74
    v_ashrrev_i32 v60, 31, v76
    v_ashrrev_i32 v61, 31, v78
    v_sub_u32 v73, v73, v58
    v_sub_u32 v75, v75, v59
    v_sub_u32 v77, v77, v60
    v_sub_u32 v79, v79, v61
    v_cvt_f32_i32 v72, v72
    v_cvt_f32_i32 v73, v73
    v_cvt_f32_i32 v74, v74
    v_cvt_f32_i32 v75, v75
    v_cvt_f32_i32 v76, v76
    v_cvt_f32_i32 v77, v77
    v_cvt_f32_i32 v78, v78
    v_cvt_f32_i32 v79, v79
    v_mul_f32 v72, v5, v72
    v_mul_f32 v73, v5, v73
    v_mul_f32 v74, v5, v74
    v_mul_f32 v75, v5, v75
    v_mul_f32 v76, v5, v76
    v_mul_f32 v77, v5, v77
    v_mul_f32 v78, v5, v78
    v_mul_f32 v79, v5, v79
    v_cvt_pk_f16_f32 v72, v72, v73
    v_cvt_pk_f16_f32 v73, v76, v77
    v_cvt_pk_f16_f32 v74, v74, v75
    v_cvt_pk_f16_f32 v75, v78, v79
    buffer_store_dwordx4 v[72:75], v43, s[16:19], 0 offen sc1
    v_ashrrev_i32 v58, 31, v80
    v_ashrrev_i32 v59, 31, v82
    v_ashrrev_i32 v60, 31, v84
    v_ashrrev_i32 v61, 31, v86
    v_sub_u32 v81, v81, v58
    v_sub_u32 v83, v83, v59
    v_sub_u32 v85, v85, v60
    v_sub_u32 v87, v87, v61
    v_cvt_f32_i32 v80, v80
    v_cvt_f32_i32 v81, v81
    v_cvt_f32_i32 v82, v82
    v_cvt_f32_i32 v83, v83
    v_cvt_f32_i32 v84, v84
    v_cvt_f32_i32 v85, v85
    v_cvt_f32_i32 v86, v86
    v_cvt_f32_i32 v87, v87
    v_mul_f32 v80, v5, v80
    v_mul_f32 v81, v5, v81
    v_mul_f32 v82, v5, v82
    v_mul_f32 v83, v5, v83
    v_mul_f32 v84, v5, v84
    v_mul_f32 v85, v5, v85
    v_mul_f32 v86, v5, v86
    v_mul_f32 v87, v5, v87
    v_cvt_pk_f16_f32 v80, v80, v81
    v_cvt_pk_f16_f32 v81, v84, v85
    v_cvt_pk_f16_f32 v82, v82, v83
    v_cvt_pk_f16_f32 v83, v86, v87
    buffer_store_dwordx4 v[80:83], v44, s[16:19], 0 offen sc1
    v_ashrrev_i32 v58, 31, v88
    v_ashrrev_i32 v59, 31, v90
    v_ashrrev_i32 v60, 31, v92
    v_ashrrev_i32 v61, 31, v94
    v_sub_u32 v89, v89, v58
    v_sub_u32 v91, v91, v59
    v_sub_u32 v93, v93, v60
    v_sub_u32 v95, v95, v61
    v_cvt_f32_i32 v88, v88
    v_cvt_f32_i32 v89, v89
    v_cvt_f32_i32 v90, v90
    v_cvt_f32_i32 v91, v91
    v_cvt_f32_i32 v92, v92
    v_cvt_f32_i32 v93, v93
    v_cvt_f32_i32 v94, v94
    v_cvt_f32_i32 v95, v95
    v_mul_f32 v88, v2, v88
    v_mul_f32 v89, v2, v89
    v_mul_f32 v90, v2, v90
    v_mul_f32 v91, v2, v91
    v_mul_f32 v92, v2, v92
    v_mul_f32 v93, v2, v93
    v_mul_f32 v94, v2, v94
    v_mul_f32 v95, v2, v95
k2_epj:
    s_lshl_b32 s80, s28, 16
    s_and_b32 s81, s28, 0xffff0000
    s_lshl_b32 s82, s29, 16
    s_and_b32 s83, s29, 0xffff0000
    s_lshl_b32 s84, s30, 16
    s_and_b32 s85, s30, 0xffff0000
    s_lshl_b32 s86, s31, 16
    s_and_b32 s87, s31, 0xffff0000
    v_and_b32 v123, v6, v122
    v_lshlrev_b32 v122, 16, v122
    v_pk_add_f32 v[16:17], v[122:123], s[80:81] op_sel:[0,0] op_sel_hi:[0,1] neg_lo:[0,1] neg_hi:[0,1]
    v_pk_add_f32 v[18:19], v[122:123], s[82:83] op_sel:[0,0] op_sel_hi:[0,1] neg_lo:[0,1] neg_hi:[0,1]
    v_pk_add_f32 v[20:21], v[122:123], s[84:85] op_sel:[0,0] op_sel_hi:[0,1] neg_lo:[0,1] neg_hi:[0,1]
    v_pk_add_f32 v[22:23], v[122:123], s[86:87] op_sel:[0,0] op_sel_hi:[0,1] neg_lo:[0,1] neg_hi:[0,1]
    v_pk_add_f32 v[24:25], v[122:123], s[80:81] op_sel:[1,0] op_sel_hi:[1,1] neg_lo:[0,1] neg_hi:[0,1]
    v_pk_add_f32 v[26:27], v[122:123], s[82:83] op_sel:[1,0] op_sel_hi:[1,1] neg_lo:[0,1] neg_hi:[0,1]
    v_pk_add_f32 v[28:29], v[122:123], s[84:85] op_sel:[1,0] op_sel_hi:[1,1] neg_lo:[0,1] neg_hi:[0,1]
    v_pk_add_f32 v[30:31], v[122:123], s[86:87] op_sel:[1,0] op_sel_hi:[1,1] neg_lo:[0,1] neg_hi:[0,1]
    s_load_dwordx8 s[80:87], s[20:21], 0
    s_load_dwordx8 s[88:95], s[42:43], 0
    v_cvt_pk_bf16_f32 v17, v16, v17
    v_lshlrev_b32 v16, 16, v17
    v_and_b32 v17, v6, v17
    v_cvt_pk_bf16_f32 v19, v18, v19
    v_lshlrev_b32 v18, 16, v19
    v_and_b32 v19, v6, v19
    v_cvt_pk_bf16_f32 v21, v20, v21
    v_lshlrev_b32 v20, 16, v21
    v_and_b32 v21, v6, v21
    v_cvt_pk_bf16_f32 v23, v22, v23
    v_lshlrev_b32 v22, 16, v23
    v_and_b32 v23, v6, v23
    v_cvt_pk_bf16_f32 v25, v24, v25
    v_lshlrev_b32 v24, 16, v25
    v_and_b32 v25, v6, v25
    v_cvt_pk_bf16_f32 v27, v26, v27
    v_lshlrev_b32 v26, 16, v27
    v_and_b32 v27, v6, v27
    v_cvt_pk_bf16_f32 v29, v28, v29
    v_lshlrev_b32 v28, 16, v29
    v_and_b32 v29, v6, v29
    v_cvt_pk_bf16_f32 v31, v30, v31
    v_lshlrev_b32 v30, 16, v31
    v_and_b32 v31, v6, v31
    v_mul_f32 v16, v16, v16
    v_mul_f32 v17, v17, v17
    v_mul_f32 v18, v18, v18
    v_mul_f32 v19, v19, v19
    v_mul_f32 v20, v20, v20
    v_mul_f32 v21, v21, v21
    v_mul_f32 v22, v22, v22
    v_mul_f32 v23, v23, v23
    v_mul_f32 v24, v24, v24
    v_mul_f32 v25, v25, v25
    v_mul_f32 v26, v26, v26
    v_mul_f32 v27, v27, v27
    v_mul_f32 v28, v28, v28
    v_mul_f32 v29, v29, v29
    v_mul_f32 v30, v30, v30
    v_mul_f32 v31, v31, v31
    v_cvt_pk_bf16_f32 v17, v16, v17
    v_lshlrev_b32 v16, 16, v17
    v_and_b32 v17, v6, v17
    v_cvt_pk_bf16_f32 v19, v18, v19
    v_lshlrev_b32 v18, 16, v19
    v_and_b32 v19, v6, v19
    v_cvt_pk_bf16_f32 v21, v20, v21
    v_lshlrev_b32 v20, 16, v21
    v_and_b32 v21, v6, v21
    v_cvt_pk_bf16_f32 v23, v22, v23
    v_lshlrev_b32 v22, 16, v23
    v_and_b32 v23, v6, v23
    v_cvt_pk_bf16_f32 v25, v24, v25
    v_lshlrev_b32 v24, 16, v25
    v_and_b32 v25, v6, v25
    v_cvt_pk_bf16_f32 v27, v26, v27
    v_lshlrev_b32 v26, 16, v27
    v_and_b32 v27, v6, v27
    v_cvt_pk_bf16_f32 v29, v28, v29
    v_lshlrev_b32 v28, 16, v29
    v_and_b32 v29, v6, v29
    v_cvt_pk_bf16_f32 v31, v30, v31
    v_lshlrev_b32 v30, 16, v31
    v_and_b32 v31, v6, v31
    v_mul_f32 v16, 0xc1200000, v16
    v_mul_f32 v17, 0xc1200000, v17
    v_mul_f32 v18, 0xc1200000, v18
    v_mul_f32 v19, 0xc1200000, v19
    v_mul_f32 v20, 0xc1200000, v20
    v_mul_f32 v21, 0xc1200000, v21
    v_mul_f32 v22, 0xc1200000, v22
    v_mul_f32 v23, 0xc1200000, v23
    v_mul_f32 v24, 0xc1200000, v24
    v_mul_f32 v25, 0xc1200000, v25
    v_mul_f32 v26, 0xc1200000, v26
    v_mul_f32 v27, 0xc1200000, v27
    v_mul_f32 v28, 0xc1200000, v28
    v_mul_f32 v29, 0xc1200000, v29
    v_mul_f32 v30, 0xc1200000, v30
    v_mul_f32 v31, 0xc1200000, v31
    v_cvt_pk_bf16_f32 v17, v16, v17
    v_lshlrev_b32 v16, 16, v17
    v_and_b32 v17, v6, v17
    v_cvt_pk_bf16_f32 v19, v18, v19
    v_lshlrev_b32 v18, 16, v19
    v_and_b32 v19, v6, v19
    v_cvt_pk_bf16_f32 v21, v20, v21
    v_lshlrev_b32 v20, 16, v21
    v_and_b32 v21, v6, v21
    v_cvt_pk_bf16_f32 v23, v22, v23
    v_lshlrev_b32 v22, 16, v23
    v_and_b32 v23, v6, v23
    v_cvt_pk_bf16_f32 v25, v24, v25
    v_lshlrev_b32 v24, 16, v25
    v_and_b32 v25, v6, v25
    v_cvt_pk_bf16_f32 v27, v26, v27
    v_lshlrev_b32 v26, 16, v27
    v_and_b32 v27, v6, v27
    v_cvt_pk_bf16_f32 v29, v28, v29
    v_lshlrev_b32 v28, 16, v29
    v_and_b32 v29, v6, v29
    v_cvt_pk_bf16_f32 v31, v30, v31
    v_lshlrev_b32 v30, 16, v31
    v_and_b32 v31, v6, v31
    s_waitcnt vmcnt(0)
    s_barrier
    v_mul_f32 v16, 0x3fb8aa3b, v16
    v_mul_f32 v17, 0x3fb8aa3b, v17
    v_mul_f32 v18, 0x3fb8aa3b, v18
    v_mul_f32 v19, 0x3fb8aa3b, v19
    v_mul_f32 v20, 0x3fb8aa3b, v20
    v_mul_f32 v21, 0x3fb8aa3b, v21
    v_mul_f32 v22, 0x3fb8aa3b, v22
    v_mul_f32 v23, 0x3fb8aa3b, v23
    v_mul_f32 v24, 0x3fb8aa3b, v24
    v_mul_f32 v25, 0x3fb8aa3b, v25
    v_mul_f32 v26, 0x3fb8aa3b, v26
    v_mul_f32 v27, 0x3fb8aa3b, v27
    v_mul_f32 v28, 0x3fb8aa3b, v28
    v_mul_f32 v29, 0x3fb8aa3b, v29
    v_mul_f32 v30, 0x3fb8aa3b, v30
    v_mul_f32 v31, 0x3fb8aa3b, v31
    v_exp_f32 v16, v16
    v_exp_f32 v17, v17
    v_exp_f32 v18, v18
    v_exp_f32 v19, v19
    v_exp_f32 v20, v20
    v_exp_f32 v21, v21
    v_exp_f32 v22, v22
    v_exp_f32 v23, v23
    v_exp_f32 v24, v24
    v_exp_f32 v25, v25
    v_exp_f32 v26, v26
    v_exp_f32 v27, v27
    v_exp_f32 v28, v28
    v_exp_f32 v29, v29
    v_exp_f32 v30, v30
    v_exp_f32 v31, v31
    s_nop 0
    v_cvt_pk_bf16_f32 v48, v16, v17
    v_cvt_pk_bf16_f32 v49, v18, v19
    v_cvt_pk_bf16_f32 v50, v20, v21
    v_cvt_pk_bf16_f32 v51, v22, v23
    v_cvt_pk_bf16_f32 v52, v24, v25
    v_cvt_pk_bf16_f32 v53, v26, v27
    v_cvt_pk_bf16_f32 v54, v28, v29
    v_cvt_pk_bf16_f32 v55, v30, v31
    s_pack_ll_b32_b16 s40, s48, s50
    v_dot2_f32_bf16 v40, v48, s40, 0
    v_dot2_f32_bf16 v44, v52, s40, 0
    s_pack_hh_b32_b16 s41, s48, s50
    v_dot2_f32_bf16 v41, v48, s41, 0
    v_dot2_f32_bf16 v45, v52, s41, 0
    s_pack_ll_b32_b16 s42, s49, s51
    v_dot2_f32_bf16 v42, v48, s42, 0
    v_dot2_f32_bf16 v46, v52, s42, 0
    s_pack_hh_b32_b16 s43, s49, s51
    v_dot2_f32_bf16 v43, v48, s43, 0
    v_dot2_f32_bf16 v47, v52, s43, 0
    s_pack_ll_b32_b16 s40, s52, s54
    v_dot2_f32_bf16 v40, v49, s40, v40
    v_dot2_f32_bf16 v44, v53, s40, v44
    s_pack_hh_b32_b16 s41, s52, s54
    v_dot2_f32_bf16 v41, v49, s41, v41
    v_dot2_f32_bf16 v45, v53, s41, v45
    s_pack_ll_b32_b16 s42, s53, s55
    v_dot2_f32_bf16 v42, v49, s42, v42
    v_dot2_f32_bf16 v46, v53, s42, v46
    s_pack_hh_b32_b16 s43, s53, s55
    v_dot2_f32_bf16 v43, v49, s43, v43
    v_dot2_f32_bf16 v47, v53, s43, v47
    s_pack_ll_b32_b16 s40, s56, s58
    v_dot2_f32_bf16 v40, v50, s40, v40
    v_dot2_f32_bf16 v44, v54, s40, v44
    s_pack_hh_b32_b16 s41, s56, s58
    v_dot2_f32_bf16 v41, v50, s41, v41
    v_dot2_f32_bf16 v45, v54, s41, v45
    s_pack_ll_b32_b16 s42, s57, s59
    v_dot2_f32_bf16 v42, v50, s42, v42
    v_dot2_f32_bf16 v46, v54, s42, v46
    s_pack_hh_b32_b16 s43, s57, s59
    v_dot2_f32_bf16 v43, v50, s43, v43
    v_dot2_f32_bf16 v47, v54, s43, v47
    s_pack_ll_b32_b16 s40, s60, s62
    v_dot2_f32_bf16 v40, v51, s40, v40
    v_dot2_f32_bf16 v44, v55, s40, v44
    s_pack_hh_b32_b16 s41, s60, s62
    v_dot2_f32_bf16 v41, v51, s41, v41
    v_dot2_f32_bf16 v45, v55, s41, v45
    s_pack_ll_b32_b16 s42, s61, s63
    v_dot2_f32_bf16 v42, v51, s42, v42
    v_dot2_f32_bf16 v46, v55, s42, v46
    s_pack_hh_b32_b16 s43, s61, s63
    v_dot2_f32_bf16 v43, v51, s43, v43
    v_dot2_f32_bf16 v47, v55, s43, v47
    s_pack_ll_b32_b16 s40, s64, s66
    v_dot2_f32_bf16 v32, v48, s40, 0
    v_dot2_f32_bf16 v36, v52, s40, 0
    s_pack_hh_b32_b16 s41, s64, s66
    v_dot2_f32_bf16 v33, v48, s41, 0
    v_dot2_f32_bf16 v37, v52, s41, 0
    s_pack_ll_b32_b16 s42, s65, s67
    v_dot2_f32_bf16 v34, v48, s42, 0
    v_dot2_f32_bf16 v38, v52, s42, 0
    s_pack_hh_b32_b16 s43, s65, s67
    v_dot2_f32_bf16 v35, v48, s43, 0
    v_dot2_f32_bf16 v39, v52, s43, 0
    s_pack_ll_b32_b16 s40, s68, s70
    v_dot2_f32_bf16 v32, v49, s40, v32
    v_dot2_f32_bf16 v36, v53, s40, v36
    s_pack_hh_b32_b16 s41, s68, s70
    v_dot2_f32_bf16 v33, v49, s41, v33
    v_dot2_f32_bf16 v37, v53, s41, v37
    s_pack_ll_b32_b16 s42, s69, s71
    v_dot2_f32_bf16 v34, v49, s42, v34
    v_dot2_f32_bf16 v38, v53, s42, v38
    s_pack_hh_b32_b16 s43, s69, s71
    v_dot2_f32_bf16 v35, v49, s43, v35
    v_dot2_f32_bf16 v39, v53, s43, v39
    s_pack_ll_b32_b16 s40, s72, s74
    v_dot2_f32_bf16 v32, v50, s40, v32
    v_dot2_f32_bf16 v36, v54, s40, v36
    s_pack_hh_b32_b16 s41, s72, s74
    v_dot2_f32_bf16 v33, v50, s41, v33
    v_dot2_f32_bf16 v37, v54, s41, v37
    s_pack_ll_b32_b16 s42, s73, s75
    v_dot2_f32_bf16 v34, v50, s42, v34
    v_dot2_f32_bf16 v38, v54, s42, v38
    s_pack_hh_b32_b16 s43, s73, s75
    v_dot2_f32_bf16 v35, v50, s43, v35
    v_dot2_f32_bf16 v39, v54, s43, v39
    s_pack_ll_b32_b16 s40, s76, s78
    v_dot2_f32_bf16 v32, v51, s40, v32
    v_dot2_f32_bf16 v36, v55, s40, v36
    s_pack_hh_b32_b16 s41, s76, s78
    v_dot2_f32_bf16 v33, v51, s41, v33
    v_dot2_f32_bf16 v37, v55, s41, v37
    s_pack_ll_b32_b16 s42, s77, s79
    v_dot2_f32_bf16 v34, v51, s42, v34
    v_dot2_f32_bf16 v38, v55, s42, v38
    s_pack_hh_b32_b16 s43, s77, s79
    v_dot2_f32_bf16 v35, v51, s43, v35
    v_dot2_f32_bf16 v39, v55, s43, v39
    v_cvt_pk_bf16_f32 v41, v40, v41
    v_lshlrev_b32 v40, 16, v41
    v_and_b32 v41, v6, v41
    v_cvt_pk_bf16_f32 v43, v42, v43
    v_lshlrev_b32 v42, 16, v43
    v_and_b32 v43, v6, v43
    v_cvt_pk_bf16_f32 v45, v44, v45
    v_lshlrev_b32 v44, 16, v45
    v_and_b32 v45, v6, v45
    v_cvt_pk_bf16_f32 v47, v46, v47
    v_lshlrev_b32 v46, 16, v47
    v_and_b32 v47, v6, v47
    s_add_u32 s16, s22, 90177536
    s_addc_u32 s17, s23, 0
    s_mov_b32 s18, 12800000
    s_mov_b32 s19, 0x00020000
    v_mov_b32 v9, 140960
    s_add_u32 s39, s34, 1
    s_and_b32 s39, s39, 3
    s_mul_i32 s39, s39, 3200000
    v_add_u32 v56, s39, v121
    s_add_u32 s39, s34, 2
    s_and_b32 s39, s39, 3
    s_mul_i32 s39, s39, 3200000
    v_add_u32 v57, s39, v121
    s_add_u32 s39, s34, 3
    s_and_b32 s39, s39, 3
    s_mul_i32 s39, s39, 3200000
    v_add_u32 v58, s39, v121
    s_waitcnt lgkmcnt(0)
    s_barrier
    ds_read_b32 v9, v9
    s_mov_b64 exec, s[46:47]
    buffer_load_dwordx4 v[96:99], v56, s[16:19], 0 offen sc1
    buffer_load_dwordx4 v[100:103], v57, s[16:19], 0 offen sc1
    buffer_load_dwordx4 v[104:107], v58, s[16:19], 0 offen sc1
    s_waitcnt lgkmcnt(0)
    v_readfirstlane_b32 s45, v9
    v_mov_b32 v9, s3
    s_cmp_gt_u32 s45, 255
    s_cbranch_scc1 k2_fslow
    s_waitcnt vmcnt(0)
    v_fma_mix_f32 v16, v96, 1.0, v100 op_sel:[0,0,0] op_sel_hi:[1,0,1]
    v_fma_mix_f32 v16, v104, 1.0, v16 op_sel:[0,0,0] op_sel_hi:[1,0,0]
    v_fma_mix_f32 v17, v96, 1.0, v100 op_sel:[1,0,1] op_sel_hi:[1,0,1]
    v_fma_mix_f32 v17, v104, 1.0, v17 op_sel:[1,0,0] op_sel_hi:[1,0,0]
    v_fma_mix_f32 v18, v97, 1.0, v101 op_sel:[0,0,0] op_sel_hi:[1,0,1]
    v_fma_mix_f32 v18, v105, 1.0, v18 op_sel:[0,0,0] op_sel_hi:[1,0,0]
    v_fma_mix_f32 v19, v97, 1.0, v101 op_sel:[1,0,1] op_sel_hi:[1,0,1]
    v_fma_mix_f32 v19, v105, 1.0, v19 op_sel:[1,0,0] op_sel_hi:[1,0,0]
    v_fma_mix_f32 v20, v98, 1.0, v102 op_sel:[0,0,0] op_sel_hi:[1,0,1]
    v_fma_mix_f32 v20, v106, 1.0, v20 op_sel:[0,0,0] op_sel_hi:[1,0,0]
    v_fma_mix_f32 v21, v98, 1.0, v102 op_sel:[1,0,1] op_sel_hi:[1,0,1]
    v_fma_mix_f32 v21, v106, 1.0, v21 op_sel:[1,0,0] op_sel_hi:[1,0,0]
    v_fma_mix_f32 v22, v99, 1.0, v103 op_sel:[0,0,0] op_sel_hi:[1,0,1]
    v_fma_mix_f32 v22, v107, 1.0, v22 op_sel:[0,0,0] op_sel_hi:[1,0,0]
    v_fma_mix_f32 v23, v99, 1.0, v103 op_sel:[1,0,1] op_sel_hi:[1,0,1]
    v_fma_mix_f32 v23, v107, 1.0, v23 op_sel:[1,0,0] op_sel_hi:[1,0,0]
    v_fma_f32 v16, v9, v16, v88
    v_fma_f32 v17, v9, v17, v89
    v_fma_f32 v18, v9, v18, v92
    v_fma_f32 v19, v9, v19, v93
    v_fma_f32 v20, v9, v20, v90
    v_fma_f32 v21, v9, v21, v91
    v_fma_f32 v22, v9, v22, v94
    v_fma_f32 v23, v9, v23, v95
k2_fjoin:
    s_lshl_b32 s40, s80, 16
    s_and_b32 s41, s80, 0xffff0000
    v_pk_mul_f32 v[24:25], v[16:17], s[40:41] op_sel:[0,0] op_sel_hi:[0,1]
    v_pk_mul_f32 v[28:29], v[20:21], s[40:41] op_sel:[0,0] op_sel_hi:[0,1]
    s_lshl_b32 s42, s81, 16
    s_and_b32 s43, s81, 0xffff0000
    v_pk_mul_f32 v[26:27], v[16:17], s[42:43] op_sel:[0,0] op_sel_hi:[0,1]
    v_pk_mul_f32 v[30:31], v[20:21], s[42:43] op_sel:[0,0] op_sel_hi:[0,1]
    s_lshl_b32 s40, s82, 16
    s_and_b32 s41, s82, 0xffff0000
    v_pk_fma_f32 v[24:25], v[16:17], s[40:41], v[24:25] op_sel:[1,0,0] op_sel_hi:[1,1,1]
    v_pk_fma_f32 v[28:29], v[20:21], s[40:41], v[28:29] op_sel:[1,0,0] op_sel_hi:[1,1,1]
    s_lshl_b32 s42, s83, 16
    s_and_b32 s43, s83, 0xffff0000
    v_pk_fma_f32 v[26:27], v[16:17], s[42:43], v[26:27] op_sel:[1,0,0] op_sel_hi:[1,1,1]
    v_pk_fma_f32 v[30:31], v[20:21], s[42:43], v[30:31] op_sel:[1,0,0] op_sel_hi:[1,1,1]
    s_lshl_b32 s40, s84, 16
    s_and_b32 s41, s84, 0xffff0000
    v_pk_fma_f32 v[24:25], v[18:19], s[40:41], v[24:25] op_sel:[0,0,0] op_sel_hi:[0,1,1]
    v_pk_fma_f32 v[28:29], v[22:23], s[40:41], v[28:29] op_sel:[0,0,0] op_sel_hi:[0,1,1]
    s_lshl_b32 s42, s85, 16
    s_and_b32 s43, s85, 0xffff0000
    v_pk_fma_f32 v[26:27], v[18:19], s[42:43], v[26:27] op_sel:[0,0,0] op_sel_hi:[0,1,1]
    v_pk_fma_f32 v[30:31], v[22:23], s[42:43], v[30:31] op_sel:[0,0,0] op_sel_hi:[0,1,1]
    s_lshl_b32 s40, s86, 16
    s_and_b32 s41, s86, 0xffff0000
    v_pk_fma_f32 v[24:25], v[18:19], s[40:41], v[24:25] op_sel:[1,0,0] op_sel_hi:[1,1,1]
    v_pk_fma_f32 v[28:29], v[22:23], s[40:41], v[28:29] op_sel:[1,0,0] op_sel_hi:[1,1,1]
    s_lshl_b32 s42, s87, 16
    s_and_b32 s43, s87, 0xffff0000
    v_pk_fma_f32 v[26:27], v[18:19], s[42:43], v[26:27] op_sel:[1,0,0] op_sel_hi:[1,1,1]
    v_pk_fma_f32 v[30:31], v[22:23], s[42:43], v[30:31] op_sel:[1,0,0] op_sel_hi:[1,1,1]
    v_mul_f32 v24, v24, v32
    v_mul_f32 v25, v25, v33
    v_mul_f32 v26, v26, v34
    v_mul_f32 v27, v27, v35
    v_mul_f32 v28, v28, v36
    v_mul_f32 v29, v29, v37
    v_mul_f32 v30, v30, v38
    v_mul_f32 v31, v31, v39
    v_cvt_pk_bf16_f32 v48, v24, v25
    v_cvt_pk_bf16_f32 v49, v26, v27
    v_cvt_pk_bf16_f32 v52, v28, v29
    v_cvt_pk_bf16_f32 v53, v30, v31
    s_pack_ll_b32_b16 s40, s88, s90
    v_dot2_f32_bf16 v32, v48, s40, 0
    v_dot2_f32_bf16 v36, v52, s40, 0
    s_pack_hh_b32_b16 s41, s88, s90
    v_dot2_f32_bf16 v33, v48, s41, 0
    v_dot2_f32_bf16 v37, v52, s41, 0
    s_pack_ll_b32_b16 s42, s89, s91
    v_dot2_f32_bf16 v34, v48, s42, 0
    v_dot2_f32_bf16 v38, v52, s42, 0
    s_pack_hh_b32_b16 s43, s89, s91
    v_dot2_f32_bf16 v35, v48, s43, 0
    v_dot2_f32_bf16 v39, v52, s43, 0
    s_pack_ll_b32_b16 s40, s92, s94
    v_dot2_f32_bf16 v32, v49, s40, v32
    v_dot2_f32_bf16 v36, v53, s40, v36
    s_pack_hh_b32_b16 s41, s92, s94
    v_dot2_f32_bf16 v33, v49, s41, v33
    v_dot2_f32_bf16 v37, v53, s41, v37
    s_pack_ll_b32_b16 s42, s93, s95
    v_dot2_f32_bf16 v34, v49, s42, v34
    v_dot2_f32_bf16 v38, v53, s42, v38
    s_pack_hh_b32_b16 s43, s93, s95
    v_dot2_f32_bf16 v35, v49, s43, v35
    v_dot2_f32_bf16 v39, v53, s43, v39
    v_lshlrev_b32 v16, 16, v124
    v_and_b32 v17, v6, v124
    v_lshlrev_b32 v18, 16, v125
    v_and_b32 v19, v6, v125
    v_lshlrev_b32 v20, 16, v126
    v_and_b32 v21, v6, v126
    v_lshlrev_b32 v22, 16, v127
    v_and_b32 v23, v6, v127
    v_cvt_pk_bf16_f32 v33, v32, v33
    v_lshlrev_b32 v32, 16, v33
    v_and_b32 v33, v6, v33
    v_cvt_pk_bf16_f32 v35, v34, v35
    v_lshlrev_b32 v34, 16, v35
    v_and_b32 v35, v6, v35
    v_cvt_pk_bf16_f32 v37, v36, v37
    v_lshlrev_b32 v36, 16, v37
    v_and_b32 v37, v6, v37
    v_cvt_pk_bf16_f32 v39, v38, v39
    v_lshlrev_b32 v38, 16, v39
    v_and_b32 v39, v6, v39
    v_mul_f32 v32, v32, v40
    v_mul_f32 v33, v33, v41
    v_mul_f32 v34, v34, v42
    v_mul_f32 v35, v35, v43
    v_mul_f32 v36, v36, v44
    v_mul_f32 v37, v37, v45
    v_mul_f32 v38, v38, v46
    v_mul_f32 v39, v39, v47
    v_cvt_pk_bf16_f32 v33, v32, v33
    v_lshlrev_b32 v32, 16, v33
    v_and_b32 v33, v6, v33
    v_cvt_pk_bf16_f32 v35, v34, v35
    v_lshlrev_b32 v34, 16, v35
    v_and_b32 v35, v6, v35
    v_cvt_pk_bf16_f32 v37, v36, v37
    v_lshlrev_b32 v36, 16, v37
    v_and_b32 v37, v6, v37
    v_cvt_pk_bf16_f32 v39, v38, v39
    v_lshlrev_b32 v38, 16, v39
    v_and_b32 v39, v6, v39
    v_add_f32 v32, v32, v16
    v_add_f32 v33, v33, v17
    v_add_f32 v34, v34, v18
    v_add_f32 v35, v35, v19
    v_add_f32 v36, v36, v20
    v_add_f32 v37, v37, v21
    v_add_f32 v38, v38, v22
    v_add_f32 v39, v39, v23
    v_cvt_pk_bf16_f32 v124, v32, v33
    v_cvt_pk_bf16_f32 v125, v34, v35
    v_cvt_pk_bf16_f32 v126, v36, v37
    v_cvt_pk_bf16_f32 v127, v38, v39
    buffer_store_dwordx4 v[124:127], v121, s[8:11], 0 offen
k2_done:
    s_endpgm
k2_sig:
    s_add_u32 s39, s34, 8
    s_lshl_b32 s39, s37, s39
    s_add_u32 s39, s39, 1
    s_lshl_b32 s40, s33, 7
    s_lshl_b32 s41, s34, 2
    s_add_u32 s41, s41, s40
    s_mov_b64 exec, 1
    v_mov_b32 v56, s40
    v_mov_b32 v57, s39
    v_mov_b32 v58, s41
    s_mov_b32 s41, 0x200000
    s_cmp_lg_u32 s32, 15
    s_barrier
    s_cbranch_scc1 k2_sig_e
    buffer_store_dword v57, v58, s[24:27], 0 offen sc1
    buffer_load_dwordx4 v[64:67], v56, s[24:27], 0 offen sc1
    s_waitcnt vmcnt(1)
    buffer_load_dwordx4 v[68:71], v56, s[24:27], 0 offen sc1
    buffer_load_dwordx4 v[72:75], v56, s[24:27], 0 offen sc1
k2_poll:
    s_waitcnt vmcnt(2)
    v_add_u32 v57, v64, v65
    v_add3_u32 v57, v57, v66, v67
    s_nop 0
    v_readfirstlane_b32 s40, v57
    s_and_b32 s40, s40, 255
    s_cmp_ge_u32 s40, 4
    s_cbranch_scc1 k2_poll_e
    buffer_load_dwordx4 v[64:67], v56, s[24:27], 0 offen sc1
    s_waitcnt vmcnt(2)
    v_add_u32 v57, v68, v69
    v_add3_u32 v57, v57, v70, v71
    s_nop 0
    v_readfirstlane_b32 s40, v57
    s_and_b32 s40, s40, 255
    s_cmp_ge_u32 s40, 4
    s_cbranch_scc1 k2_poll_e
    buffer_load_dwordx4 v[68:71], v56, s[24:27], 0 offen sc1
    s_waitcnt vmcnt(2)
    v_add_u32 v57, v72, v73
    v_add3_u32 v57, v57, v74, v75
    s_nop 0
    v_readfirstlane_b32 s40, v57
    s_and_b32 s40, s40, 255
    s_cmp_ge_u32 s40, 4
    s_cbranch_scc1 k2_poll_e
    buffer_load_dwordx4 v[72:75], v56, s[24:27], 0 offen sc1
    s_sub_u32 s41, s41, 1
    s_cbranch_scc0 k2_poll
k2_poll_e:
    v_mov_b32 v56, 140960
    ds_write_b32 v56, v57
    s_waitcnt lgkmcnt(0)
k2_sig_e:
    s_barrier
    s_endpgm
k2_wz_da00:
    s_waitcnt lgkmcnt(0)
    s_branch k2_w_da00
k2_accf_d00:
    buffer_load_dword v108, v4, s[12:15], 0 offen offset:0
    buffer_load_dword v109, v4, s[12:15], 0 offen offset:256
    buffer_load_dword v110, v4, s[12:15], 0 offen offset:512
    buffer_load_dword v111, v4, s[12:15], 0 offen offset:768
    v_and_b32 v12, v6, v88
    v_and_b32 v13, 0xfff8, v88
    v_add_u32 v13, 40960, v13
    v_lshlrev_b32 v42, 16, v24
    v_and_b32 v43, v6, v24
    v_lshlrev_b32 v44, 16, v25
    v_and_b32 v45, v6, v25
    v_mul_f32 v42, v42, v12
    v_mul_f32 v43, v43, v12
    v_mul_f32 v44, v44, v12
    v_mul_f32 v45, v45, v12
    s_mov_b64 exec, s[56:57]
    ds_add_f32 v13, v42
    ds_add_f32 v13, v43 offset:4
    ds_add_f32 v13, v44 offset:50000
    ds_add_f32 v13, v45 offset:50004
    s_mov_b64 exec, -1
    s_waitcnt lgkmcnt(0)
    v_and_b32 v12, v6, v90
    v_and_b32 v13, 0xfff8, v90
    v_add_u32 v13, 40960, v13
    v_lshlrev_b32 v42, 16, v26
    v_and_b32 v43, v6, v26
    v_lshlrev_b32 v44, 16, v27
    v_and_b32 v45, v6, v27
    v_mul_f32 v42, v42, v12
    v_mul_f32 v43, v43, v12
    v_mul_f32 v44, v44, v12
    v_mul_f32 v45, v45, v12
    s_mov_b64 exec, s[58:59]
    ds_add_f32 v13, v42
    ds_add_f32 v13, v43 offset:4
    ds_add_f32 v13, v44 offset:50000
    ds_add_f32 v13, v45 offset:50004
    s_mov_b64 exec, -1
    s_waitcnt lgkmcnt(0)
    v_and_b32 v12, v6, v91
    v_and_b32 v13, 0xfff8, v91
    v_add_u32 v13, 40960, v13
    v_lshlrev_b32 v42, 16, v28
    v_and_b32 v43, v6, v28
    v_lshlrev_b32 v44, 16, v29
    v_and_b32 v45, v6, v29
    v_mul_f32 v42, v42, v12
    v_mul_f32 v43, v43, v12
    v_mul_f32 v44, v44, v12
    v_mul_f32 v45, v45, v12
    s_mov_b64 exec, s[60:61]
    ds_add_f32 v13, v42
    ds_add_f32 v13, v43 offset:4
    ds_add_f32 v13, v44 offset:50000
    ds_add_f32 v13, v45 offset:50004
    s_mov_b64 exec, -1
    s_waitcnt lgkmcnt(0)
    s_mov_b64 s[56:57], 0
    s_mov_b64 s[58:59], 0
    s_mov_b64 s[60:61], 0
    s_branch k2_acce_d00
k2_wz_db00:
    s_waitcnt lgkmcnt(0)
    s_branch k2_w_db00
k2_wz_da01:
    s_waitcnt lgkmcnt(0)
    s_branch k2_w_da01
k2_accf_d01:
    buffer_load_dword v14, v4, s[12:15], 0 offen offset:0
    buffer_load_dword v15, v4, s[12:15], 0 offen offset:256
    buffer_load_dword v16, v4, s[12:15], 0 offen offset:512
    buffer_load_dword v17, v4, s[12:15], 0 offen offset:768
    v_and_b32 v12, v6, v92
    v_and_b32 v13, 0xfff8, v92
    v_add_u32 v13, 40960, v13
    v_lshlrev_b32 v42, 16, v24
    v_and_b32 v43, v6, v24
    v_lshlrev_b32 v44, 16, v25
    v_and_b32 v45, v6, v25
    v_mul_f32 v42, v42, v12
    v_mul_f32 v43, v43, v12
    v_mul_f32 v44, v44, v12
    v_mul_f32 v45, v45, v12
    s_mov_b64 exec, s[62:63]
    ds_add_f32 v13, v42
    ds_add_f32 v13, v43 offset:4
    ds_add_f32 v13, v44 offset:50000
    ds_add_f32 v13, v45 offset:50004
    s_mov_b64 exec, -1
    s_waitcnt lgkmcnt(0)
    v_and_b32 v12, v6, v94
    v_and_b32 v13, 0xfff8, v94
    v_add_u32 v13, 40960, v13
    v_lshlrev_b32 v42, 16, v26
    v_and_b32 v43, v6, v26
    v_lshlrev_b32 v44, 16, v27
    v_and_b32 v45, v6, v27
    v_mul_f32 v42, v42, v12
    v_mul_f32 v43, v43, v12
    v_mul_f32 v44, v44, v12
    v_mul_f32 v45, v45, v12
    s_mov_b64 exec, s[64:65]
    ds_add_f32 v13, v42
    ds_add_f32 v13, v43 offset:4
    ds_add_f32 v13, v44 offset:50000
    ds_add_f32 v13, v45 offset:50004
    s_mov_b64 exec, -1
    s_waitcnt lgkmcnt(0)
    v_and_b32 v12, v6, v95
    v_and_b32 v13, 0xfff8, v95
    v_add_u32 v13, 40960, v13
    v_lshlrev_b32 v42, 16, v50
    v_and_b32 v43, v6, v50
    v_lshlrev_b32 v44, 16, v51
    v_and_b32 v45, v6, v51
    v_mul_f32 v42, v42, v12
    v_mul_f32 v43, v43, v12
    v_mul_f32 v44, v44, v12
    v_mul_f32 v45, v45, v12
    s_mov_b64 exec, s[66:67]
    ds_add_f32 v13, v42
    ds_add_f32 v13, v43 offset:4
    ds_add_f32 v13, v44 offset:50000
    ds_add_f32 v13, v45 offset:50004
    s_mov_b64 exec, -1
    s_waitcnt lgkmcnt(0)
    s_mov_b64 s[62:63], 0
    s_mov_b64 s[64:65], 0
    s_mov_b64 s[66:67], 0
    s_branch k2_acce_d01
k2_ey_d0:
    buffer_load_dword v122, v122, s[16:19], 0 offen
    buffer_load_dwordx4 v[124:127], v121, s[8:11], 0 offen
    s_branch k2_en_d0
k2_wz_db01:
    s_waitcnt lgkmcnt(0)
    s_branch k2_w_db01
k2_wz_da02:
    s_waitcnt lgkmcnt(0)
    s_branch k2_w_da02
k2_accf_d02:
    buffer_load_dword v108, v4, s[12:15], 0 offen offset:0
    buffer_load_dword v109, v4, s[12:15], 0 offen offset:256
    buffer_load_dword v110, v4, s[12:15], 0 offen offset:512
    buffer_load_dword v111, v4, s[12:15], 0 offen offset:768
    v_and_b32 v12, v6, v96
    v_and_b32 v13, 0xfff8, v96
    v_add_u32 v13, 40960, v13
    v_lshlrev_b32 v42, 16, v24
    v_and_b32 v43, v6, v24
    v_lshlrev_b32 v44, 16, v25
    v_and_b32 v45, v6, v25
    v_mul_f32 v42, v42, v12
    v_mul_f32 v43, v43, v12
    v_mul_f32 v44, v44, v12
    v_mul_f32 v45, v45, v12
    s_mov_b64 exec, s[56:57]
    ds_add_f32 v13, v42
    ds_add_f32 v13, v43 offset:4
    ds_add_f32 v13, v44 offset:50000
    ds_add_f32 v13, v45 offset:50004
    s_mov_b64 exec, -1
    s_waitcnt lgkmcnt(0)
    v_and_b32 v12, v6, v98
    v_and_b32 v13, 0xfff8, v98
    v_add_u32 v13, 40960, v13
    v_lshlrev_b32 v42, 16, v26
    v_and_b32 v43, v6, v26
    v_lshlrev_b32 v44, 16, v27
    v_and_b32 v45, v6, v27
    v_mul_f32 v42, v42, v12
    v_mul_f32 v43, v43, v12
    v_mul_f32 v44, v44, v12
    v_mul_f32 v45, v45, v12
    s_mov_b64 exec, s[58:59]
    ds_add_f32 v13, v42
    ds_add_f32 v13, v43 offset:4
    ds_add_f32 v13, v44 offset:50000
    ds_add_f32 v13, v45 offset:50004
    s_mov_b64 exec, -1
    s_waitcnt lgkmcnt(0)
    v_and_b32 v12, v6, v99
    v_and_b32 v13, 0xfff8, v99
    v_add_u32 v13, 40960, v13
    v_lshlrev_b32 v42, 16, v28
    v_and_b32 v43, v6, v28
    v_lshlrev_b32 v44, 16, v29
    v_and_b32 v45, v6, v29
    v_mul_f32 v42, v42, v12
    v_mul_f32 v43, v43, v12
    v_mul_f32 v44, v44, v12
    v_mul_f32 v45, v45, v12
    s_mov_b64 exec, s[60:61]
    ds_add_f32 v13, v42
    ds_add_f32 v13, v43 offset:4
    ds_add_f32 v13, v44 offset:50000
    ds_add_f32 v13, v45 offset:50004
    s_mov_b64 exec, -1
    s_waitcnt lgkmcnt(0)
    s_mov_b64 s[56:57], 0
    s_mov_b64 s[58:59], 0
    s_mov_b64 s[60:61], 0
    s_branch k2_acce_d02
k2_wz_db02:
    s_waitcnt lgkmcnt(0)
    s_branch k2_w_db02
k2_wz_da03:
    s_waitcnt lgkmcnt(0)
    s_branch k2_w_da03
k2_accf_d03:
    buffer_load_dword v14, v4, s[12:15], 0 offen offset:0
    buffer_load_dword v15, v4, s[12:15], 0 offen offset:256
    buffer_load_dword v16, v4, s[12:15], 0 offen offset:512
    buffer_load_dword v17, v4, s[12:15], 0 offen offset:768
    v_and_b32 v12, v6, v100
    v_and_b32 v13, 0xfff8, v100
    v_add_u32 v13, 40960, v13
    v_lshlrev_b32 v42, 16, v24
    v_and_b32 v43, v6, v24
    v_lshlrev_b32 v44, 16, v25
    v_and_b32 v45, v6, v25
    v_mul_f32 v42, v42, v12
    v_mul_f32 v43, v43, v12
    v_mul_f32 v44, v44, v12
    v_mul_f32 v45, v45, v12
    s_mov_b64 exec, s[62:63]
    ds_add_f32 v13, v42
    ds_add_f32 v13, v43 offset:4
    ds_add_f32 v13, v44 offset:50000
    ds_add_f32 v13, v45 offset:50004
    s_mov_b64 exec, -1
    s_waitcnt lgkmcnt(0)
    v_and_b32 v12, v6, v102
    v_and_b32 v13, 0xfff8, v102
    v_add_u32 v13, 40960, v13
    v_lshlrev_b32 v42, 16, v26
    v_and_b32 v43, v6, v26
    v_lshlrev_b32 v44, 16, v27
    v_and_b32 v45, v6, v27
    v_mul_f32 v42, v42, v12
    v_mul_f32 v43, v43, v12
    v_mul_f32 v44, v44, v12
    v_mul_f32 v45, v45, v12
    s_mov_b64 exec, s[64:65]
    ds_add_f32 v13, v42
    ds_add_f32 v13, v43 offset:4
    ds_add_f32 v13, v44 offset:50000
    ds_add_f32 v13, v45 offset:50004
    s_mov_b64 exec, -1
    s_waitcnt lgkmcnt(0)
    v_and_b32 v12, v6, v103
    v_and_b32 v13, 0xfff8, v103
    v_add_u32 v13, 40960, v13
    v_lshlrev_b32 v42, 16, v50
    v_and_b32 v43, v6, v50
    v_lshlrev_b32 v44, 16, v51
    v_and_b32 v45, v6, v51
    v_mul_f32 v42, v42, v12
    v_mul_f32 v43, v43, v12
    v_mul_f32 v44, v44, v12
    v_mul_f32 v45, v45, v12
    s_mov_b64 exec, s[66:67]
    ds_add_f32 v13, v42
    ds_add_f32 v13, v43 offset:4
    ds_add_f32 v13, v44 offset:50000
    ds_add_f32 v13, v45 offset:50004
    s_mov_b64 exec, -1
    s_waitcnt lgkmcnt(0)
    s_mov_b64 s[62:63], 0
    s_mov_b64 s[64:65], 0
    s_mov_b64 s[66:67], 0
    s_branch k2_acce_d03
k2_wz_db03:
    s_waitcnt lgkmcnt(0)
    s_branch k2_w_db03
k2_wz_da10:
    s_waitcnt lgkmcnt(0)
    s_branch k2_w_da10
k2_accf_d10:
    buffer_load_dword v108, v4, s[12:15], 0 offen offset:0
    buffer_load_dword v109, v4, s[12:15], 0 offen offset:256
    buffer_load_dword v110, v4, s[12:15], 0 offen offset:512
    buffer_load_dword v111, v4, s[12:15], 0 offen offset:768
    v_and_b32 v12, v6, v88
    v_and_b32 v13, 0xfff8, v88
    v_add_u32 v13, 40960, v13
    v_lshlrev_b32 v42, 16, v24
    v_and_b32 v43, v6, v24
    v_lshlrev_b32 v44, 16, v25
    v_and_b32 v45, v6, v25
    v_mul_f32 v42, v42, v12
    v_mul_f32 v43, v43, v12
    v_mul_f32 v44, v44, v12
    v_mul_f32 v45, v45, v12
    s_mov_b64 exec, s[56:57]
    ds_add_f32 v13, v42
    ds_add_f32 v13, v43 offset:4
    ds_add_f32 v13, v44 offset:50000
    ds_add_f32 v13, v45 offset:50004
    s_mov_b64 exec, -1
    s_waitcnt lgkmcnt(0)
    v_and_b32 v12, v6, v90
    v_and_b32 v13, 0xfff8, v90
    v_add_u32 v13, 40960, v13
    v_lshlrev_b32 v42, 16, v26
    v_and_b32 v43, v6, v26
    v_lshlrev_b32 v44, 16, v27
    v_and_b32 v45, v6, v27
    v_mul_f32 v42, v42, v12
    v_mul_f32 v43, v43, v12
    v_mul_f32 v44, v44, v12
    v_mul_f32 v45, v45, v12
    s_mov_b64 exec, s[58:59]
    ds_add_f32 v13, v42
    ds_add_f32 v13, v43 offset:4
    ds_add_f32 v13, v44 offset:50000
    ds_add_f32 v13, v45 offset:50004
    s_mov_b64 exec, -1
    s_waitcnt lgkmcnt(0)
    v_and_b32 v12, v6, v91
    v_and_b32 v13, 0xfff8, v91
    v_add_u32 v13, 40960, v13
    v_lshlrev_b32 v42, 16, v28
    v_and_b32 v43, v6, v28
    v_lshlrev_b32 v44, 16, v29
    v_and_b32 v45, v6, v29
    v_mul_f32 v42, v42, v12
    v_mul_f32 v43, v43, v12
    v_mul_f32 v44, v44, v12
    v_mul_f32 v45, v45, v12
    s_mov_b64 exec, s[60:61]
    ds_add_f32 v13, v42
    ds_add_f32 v13, v43 offset:4
    ds_add_f32 v13, v44 offset:50000
    ds_add_f32 v13, v45 offset:50004
    s_mov_b64 exec, -1
    s_waitcnt lgkmcnt(0)
    s_mov_b64 s[56:57], 0
    s_mov_b64 s[58:59], 0
    s_mov_b64 s[60:61], 0
    s_branch k2_acce_d10
k2_wz_db10:
    s_waitcnt lgkmcnt(0)
    s_branch k2_w_db10
k2_wz_da11:
    s_waitcnt lgkmcnt(0)
    s_branch k2_w_da11
k2_accf_d11:
    buffer_load_dword v14, v4, s[12:15], 0 offen offset:0
    buffer_load_dword v15, v4, s[12:15], 0 offen offset:256
    buffer_load_dword v16, v4, s[12:15], 0 offen offset:512
    buffer_load_dword v17, v4, s[12:15], 0 offen offset:768
    v_and_b32 v12, v6, v92
    v_and_b32 v13, 0xfff8, v92
    v_add_u32 v13, 40960, v13
    v_lshlrev_b32 v42, 16, v24
    v_and_b32 v43, v6, v24
    v_lshlrev_b32 v44, 16, v25
    v_and_b32 v45, v6, v25
    v_mul_f32 v42, v42, v12
    v_mul_f32 v43, v43, v12
    v_mul_f32 v44, v44, v12
    v_mul_f32 v45, v45, v12
    s_mov_b64 exec, s[62:63]
    ds_add_f32 v13, v42
    ds_add_f32 v13, v43 offset:4
    ds_add_f32 v13, v44 offset:50000
    ds_add_f32 v13, v45 offset:50004
    s_mov_b64 exec, -1
    s_waitcnt lgkmcnt(0)
    v_and_b32 v12, v6, v94
    v_and_b32 v13, 0xfff8, v94
    v_add_u32 v13, 40960, v13
    v_lshlrev_b32 v42, 16, v26
    v_and_b32 v43, v6, v26
    v_lshlrev_b32 v44, 16, v27
    v_and_b32 v45, v6, v27
    v_mul_f32 v42, v42, v12
    v_mul_f32 v43, v43, v12
    v_mul_f32 v44, v44, v12
    v_mul_f32 v45, v45, v12
    s_mov_b64 exec, s[64:65]
    ds_add_f32 v13, v42
    ds_add_f32 v13, v43 offset:4
    ds_add_f32 v13, v44 offset:50000
    ds_add_f32 v13, v45 offset:50004
    s_mov_b64 exec, -1
    s_waitcnt lgkmcnt(0)
    v_and_b32 v12, v6, v95
    v_and_b32 v13, 0xfff8, v95
    v_add_u32 v13, 40960, v13
    v_lshlrev_b32 v42, 16, v50
    v_and_b32 v43, v6, v50
    v_lshlrev_b32 v44, 16, v51
    v_and_b32 v45, v6, v51
    v_mul_f32 v42, v42, v12
    v_mul_f32 v43, v43, v12
    v_mul_f32 v44, v44, v12
    v_mul_f32 v45, v45, v12
    s_mov_b64 exec, s[66:67]
    ds_add_f32 v13, v42
    ds_add_f32 v13, v43 offset:4
    ds_add_f32 v13, v44 offset:50000
    ds_add_f32 v13, v45 offset:50004
    s_mov_b64 exec, -1
    s_waitcnt lgkmcnt(0)
    s_mov_b64 s[62:63], 0
    s_mov_b64 s[64:65], 0
    s_mov_b64 s[66:67], 0
    s_branch k2_acce_d11
k2_ey_d1:
    buffer_load_dword v122, v122, s[16:19], 0 offen
    buffer_load_dwordx4 v[124:127], v121, s[8:11], 0 offen
    s_branch k2_en_d1
k2_wz_db11:
    s_waitcnt lgkmcnt(0)
    s_branch k2_w_db11
k2_wz_da12:
    s_waitcnt lgkmcnt(0)
    s_branch k2_w_da12
k2_accf_d12:
    buffer_load_dword v108, v4, s[12:15], 0 offen offset:0
    buffer_load_dword v109, v4, s[12:15], 0 offen offset:256
    buffer_load_dword v110, v4, s[12:15], 0 offen offset:512
    buffer_load_dword v111, v4, s[12:15], 0 offen offset:768
    v_and_b32 v12, v6, v96
    v_and_b32 v13, 0xfff8, v96
    v_add_u32 v13, 40960, v13
    v_lshlrev_b32 v42, 16, v24
    v_and_b32 v43, v6, v24
    v_lshlrev_b32 v44, 16, v25
    v_and_b32 v45, v6, v25
    v_mul_f32 v42, v42, v12
    v_mul_f32 v43, v43, v12
    v_mul_f32 v44, v44, v12
    v_mul_f32 v45, v45, v12
    s_mov_b64 exec, s[56:57]
    ds_add_f32 v13, v42
    ds_add_f32 v13, v43 offset:4
    ds_add_f32 v13, v44 offset:50000
    ds_add_f32 v13, v45 offset:50004
    s_mov_b64 exec, -1
    s_waitcnt lgkmcnt(0)
    v_and_b32 v12, v6, v98
    v_and_b32 v13, 0xfff8, v98
    v_add_u32 v13, 40960, v13
    v_lshlrev_b32 v42, 16, v26
    v_and_b32 v43, v6, v26
    v_lshlrev_b32 v44, 16, v27
    v_and_b32 v45, v6, v27
    v_mul_f32 v42, v42, v12
    v_mul_f32 v43, v43, v12
    v_mul_f32 v44, v44, v12
    v_mul_f32 v45, v45, v12
    s_mov_b64 exec, s[58:59]
    ds_add_f32 v13, v42
    ds_add_f32 v13, v43 offset:4
    ds_add_f32 v13, v44 offset:50000
    ds_add_f32 v13, v45 offset:50004
    s_mov_b64 exec, -1
    s_waitcnt lgkmcnt(0)
    v_and_b32 v12, v6, v99
    v_and_b32 v13, 0xfff8, v99
    v_add_u32 v13, 40960, v13
    v_lshlrev_b32 v42, 16, v28
    v_and_b32 v43, v6, v28
    v_lshlrev_b32 v44, 16, v29
    v_and_b32 v45, v6, v29
    v_mul_f32 v42, v42, v12
    v_mul_f32 v43, v43, v12
    v_mul_f32 v44, v44, v12
    v_mul_f32 v45, v45, v12
    s_mov_b64 exec, s[60:61]
    ds_add_f32 v13, v42
    ds_add_f32 v13, v43 offset:4
    ds_add_f32 v13, v44 offset:50000
    ds_add_f32 v13, v45 offset:50004
    s_mov_b64 exec, -1
    s_waitcnt lgkmcnt(0)
    s_mov_b64 s[56:57], 0
    s_mov_b64 s[58:59], 0
    s_mov_b64 s[60:61], 0
    s_branch k2_acce_d12
k2_wz_db12:
    s_waitcnt lgkmcnt(0)
    s_branch k2_w_db12
k2_wz_da13:
    s_waitcnt lgkmcnt(0)
    s_branch k2_w_da13
k2_accf_d13:
    buffer_load_dword v14, v4, s[12:15], 0 offen offset:0
    buffer_load_dword v15, v4, s[12:15], 0 offen offset:256
    buffer_load_dword v16, v4, s[12:15], 0 offen offset:512
    buffer_load_dword v17, v4, s[12:15], 0 offen offset:768
    v_and_b32 v12, v6, v100
    v_and_b32 v13, 0xfff8, v100
    v_add_u32 v13, 40960, v13
    v_lshlrev_b32 v42, 16, v24
    v_and_b32 v43, v6, v24
    v_lshlrev_b32 v44, 16, v25
    v_and_b32 v45, v6, v25
    v_mul_f32 v42, v42, v12
    v_mul_f32 v43, v43, v12
    v_mul_f32 v44, v44, v12
    v_mul_f32 v45, v45, v12
    s_mov_b64 exec, s[62:63]
    ds_add_f32 v13, v42
    ds_add_f32 v13, v43 offset:4
    ds_add_f32 v13, v44 offset:50000
    ds_add_f32 v13, v45 offset:50004
    s_mov_b64 exec, -1
    s_waitcnt lgkmcnt(0)
    v_and_b32 v12, v6, v102
    v_and_b32 v13, 0xfff8, v102
    v_add_u32 v13, 40960, v13
    v_lshlrev_b32 v42, 16, v26
    v_and_b32 v43, v6, v26
    v_lshlrev_b32 v44, 16, v27
    v_and_b32 v45, v6, v27
    v_mul_f32 v42, v42, v12
    v_mul_f32 v43, v43, v12
    v_mul_f32 v44, v44, v12
    v_mul_f32 v45, v45, v12
    s_mov_b64 exec, s[64:65]
    ds_add_f32 v13, v42
    ds_add_f32 v13, v43 offset:4
    ds_add_f32 v13, v44 offset:50000
    ds_add_f32 v13, v45 offset:50004
    s_mov_b64 exec, -1
    s_waitcnt lgkmcnt(0)
    v_and_b32 v12, v6, v103
    v_and_b32 v13, 0xfff8, v103
    v_add_u32 v13, 40960, v13
    v_lshlrev_b32 v42, 16, v50
    v_and_b32 v43, v6, v50
    v_lshlrev_b32 v44, 16, v51
    v_and_b32 v45, v6, v51
    v_mul_f32 v42, v42, v12
    v_mul_f32 v43, v43, v12
    v_mul_f32 v44, v44, v12
    v_mul_f32 v45, v45, v12
    s_mov_b64 exec, s[66:67]
    ds_add_f32 v13, v42
    ds_add_f32 v13, v43 offset:4
    ds_add_f32 v13, v44 offset:50000
    ds_add_f32 v13, v45 offset:50004
    s_mov_b64 exec, -1
    s_waitcnt lgkmcnt(0)
    s_mov_b64 s[62:63], 0
    s_mov_b64 s[64:65], 0
    s_mov_b64 s[66:67], 0
    s_branch k2_acce_d13
k2_wz_db13:
    s_waitcnt lgkmcnt(0)
    s_branch k2_w_db13
k2_sy_p0:
    s_movk_i32 s44, 1024
    s_add_u32 s40, s44, 1024
    v_cmp_ge_u32 s[48:49], s44, v58
    v_subrev_u32 v60, s44, v58
    v_cmp_eq_u32 s[52:53], s40, v57
    s_bcnt1_i32_b64 s39, s[48:49]
    v_add_u32 v61, -16, v60
    s_sub_u32 s39, s39, 1
    v_cmp_gt_u32 vcc, 1008, v61
    v_readlane_b32 s42, v59, s39
    v_lshrrev_b32 v60, 2, v60
    s_and_b64 s[50:51], vcc, s[54:55]
    v_cndmask_b32 v60, 0, v60, s[50:51]
    v_cndmask_b32 v61, 0, v59, s[50:51]
    ds_permute_b32 v61, v60, v61
    s_waitcnt lgkmcnt(0)
    v_cmp_ne_u32 s[48:49], 0, v61
    v_add_u32 v60, s44, v1
    s_cmp_lg_u64 s[52:53], 0
    v_max_u32_dpp v61, v61, v61 row_shr:1 row_mask:0xf bank_mask:0xf
    v_cmp_gt_u32 s[80:81], s92, v60
    s_cselect_b32 s53, 0x80000000, 0
    v_max_u32_dpp v61, v61, v61 row_shr:2 row_mask:0xf bank_mask:0xf
    s_mov_b32 s52, 0
    s_lshr_b64 s[48:49], s[48:49], 1
    v_max_u32_dpp v61, v61, v61 row_shr:4 row_mask:0xf bank_mask:0xf
    s_or_b64 s[52:53], s[52:53], s[48:49]
    s_lshr_b64 s[48:49], s[80:81], 1
    v_max_u32_dpp v61, v61, v61 row_shr:8 row_mask:0xf bank_mask:0xf
    s_andn2_b64 s[48:49], s[80:81], s[48:49]
    s_bitset0_b64 s[48:49], 63
    v_max_u32_dpp v61, v61, v61 row_bcast:15 row_mask:0xa bank_mask:0xf
    s_or_b64 s[52:53], s[52:53], s[48:49]
    s_nop 0
    v_max_u32_dpp v61, v61, v61 row_bcast:31 row_mask:0xc bank_mask:0xf
    v_max_u32 v61, s42, v61
    v_add_u32 v60, v60, v61
    v_and_b32 v61, 3, v61
    v_and_b32 v60, -16, v60
    v_cmp_eq_u32 s[48:49], 2, v61
    v_cmp_ne_u32 s[50:51], 0, v61
    v_cndmask_b32 v60, v6, v60, s[80:81]
    buffer_load_dwordx4 v[96:99], v60, s[4:7], 0 offen
    s_and_b64 s[48:49], s[48:49], s[52:53]
    s_and_b64 s[50:51], s[50:51], s[52:53]
    s_andn2_b64 s[82:83], s[80:81], s[48:49]
    s_andn2_b64 s[84:85], s[80:81], s[50:51]
    s_branch k2_ns_p0
k2_sy_p1:
    s_movk_i32 s44, 1024
    s_add_u32 s40, s44, 1024
    v_cmp_ge_u32 s[48:49], s44, v58
    v_subrev_u32 v60, s44, v58
    v_cmp_eq_u32 s[52:53], s40, v57
    s_bcnt1_i32_b64 s39, s[48:49]
    v_add_u32 v61, -16, v60
    s_sub_u32 s39, s39, 1
    v_cmp_gt_u32 vcc, 1008, v61
    v_readlane_b32 s42, v59, s39
    v_lshrrev_b32 v60, 2, v60
    s_and_b64 s[50:51], vcc, s[54:55]
    v_cndmask_b32 v60, 0, v60, s[50:51]
    v_cndmask_b32 v61, 0, v59, s[50:51]
    ds_permute_b32 v61, v60, v61
    s_waitcnt lgkmcnt(0)
    v_cmp_ne_u32 s[48:49], 0, v61
    v_add_u32 v60, s44, v1
    s_cmp_lg_u64 s[52:53], 0
    v_max_u32_dpp v61, v61, v61 row_shr:1 row_mask:0xf bank_mask:0xf
    v_cmp_gt_u32 s[86:87], s93, v60
    s_cselect_b32 s53, 0x80000000, 0
    v_max_u32_dpp v61, v61, v61 row_shr:2 row_mask:0xf bank_mask:0xf
    s_mov_b32 s52, 0
    s_lshr_b64 s[48:49], s[48:49], 1
    v_max_u32_dpp v61, v61, v61 row_shr:4 row_mask:0xf bank_mask:0xf
    s_or_b64 s[52:53], s[52:53], s[48:49]
    s_lshr_b64 s[48:49], s[86:87], 1
    v_max_u32_dpp v61, v61, v61 row_shr:8 row_mask:0xf bank_mask:0xf
    s_andn2_b64 s[48:49], s[86:87], s[48:49]
    s_bitset0_b64 s[48:49], 63
    v_max_u32_dpp v61, v61, v61 row_bcast:15 row_mask:0xa bank_mask:0xf
    s_or_b64 s[52:53], s[52:53], s[48:49]
    s_nop 0
    v_max_u32_dpp v61, v61, v61 row_bcast:31 row_mask:0xc bank_mask:0xf
    v_max_u32 v61, s42, v61
    v_add_u32 v60, v60, v61
    v_and_b32 v61, 3, v61
    v_and_b32 v60, -16, v60
    v_cmp_eq_u32 s[48:49], 2, v61
    v_cmp_ne_u32 s[50:51], 0, v61
    v_cndmask_b32 v60, v6, v60, s[86:87]
    buffer_load_dwordx4 v[100:103], v60, s[4:7], 0 offen
    s_and_b64 s[48:49], s[48:49], s[52:53]
    s_and_b64 s[50:51], s[50:51], s[52:53]
    s_andn2_b64 s[88:89], s[86:87], s[48:49]
    s_andn2_b64 s[90:91], s[86:87], s[50:51]
    s_branch k2_ns_p1
k2_xy_0:
    s_cmp_gt_u32 s92, 2048
    s_cbranch_scc1 k2_xz_0
    v_alignbit_b32 v30, v96, v97, 19
    v_lshlrev_b32 v31, 10, v97
    v_and_b32 v30, 0xfff8, v30
    v_lshlrev_b32 v32, 20, v97
    v_alignbit_b32 v31, v98, v31, 19
    v_alignbit_b32 v32, v99, v32, 19
    v_and_b32 v31, 0xfff8, v31
    v_and_b32 v32, 0xfff8, v32
    s_mov_b64 exec, s[80:81]
    ds_read_b64 v[50:51], v30
    s_mov_b64 exec, s[82:83]
    ds_read_b64 v[52:53], v31
    s_mov_b64 exec, s[84:85]
    ds_read_b64 v[54:55], v32
    s_mov_b64 exec, -1
    s_mov_b32 s94, 1
    s_branch k2_nx_0
k2_xb_0:
    s_mov_b32 s94, 0
    s_cmp_lg_u32 s37, 0
    s_cbranch_scc1 k2_xf_0
    v_and_b32 v12, v6, v96
    v_lshlrev_b32 v42, 16, v50
    v_and_b32 v43, v6, v50
    v_lshlrev_b32 v44, 16, v51
    v_and_b32 v45, v6, v51
    v_fma_f32 v42, v42, v12, v5
    v_fma_f32 v43, v43, v12, v5
    v_fma_f32 v44, v44, v12, v5
    v_fma_f32 v45, v45, v12, v5
    v_and_b32 v12, 0xfff8, v96
    v_lshl_add_u64 v[42:43], v[42:43], 0, s[46:47]
    v_add_u32 v12, 40960, v12
    v_lshl_add_u64 v[44:45], v[44:45], 0, s[46:47]
    s_mov_b64 exec, s[80:81]
    ds_add_u64 v12, v[42:43]
    ds_add_u64 v12, v[44:45] offset:50000
    s_mov_b64 exec, -1
    v_and_b32 v12, v6, v98
    v_lshlrev_b32 v42, 16, v52
    v_and_b32 v43, v6, v52
    v_lshlrev_b32 v44, 16, v53
    v_and_b32 v45, v6, v53
    v_fma_f32 v42, v42, v12, v5
    v_fma_f32 v43, v43, v12, v5
    v_fma_f32 v44, v44, v12, v5
    v_fma_f32 v45, v45, v12, v5
    v_and_b32 v12, 0xfff8, v98
    v_lshl_add_u64 v[42:43], v[42:43], 0, s[46:47]
    v_add_u32 v12, 40960, v12
    v_lshl_add_u64 v[44:45], v[44:45], 0, s[46:47]
    s_mov_b64 exec, s[82:83]
    ds_add_u64 v12, v[42:43]
    ds_add_u64 v12, v[44:45] offset:50000
    s_mov_b64 exec, -1
    v_and_b32 v12, v6, v99
    v_lshlrev_b32 v42, 16, v54
    v_and_b32 v43, v6, v54
    v_lshlrev_b32 v44, 16, v55
    v_and_b32 v45, v6, v55
    v_fma_f32 v42, v42, v12, v5
    v_fma_f32 v43, v43, v12, v5
    v_fma_f32 v44, v44, v12, v5
    v_fma_f32 v45, v45, v12, v5
    v_and_b32 v12, 0xfff8, v99
    v_lshl_add_u64 v[42:43], v[42:43], 0, s[46:47]
    v_add_u32 v12, 40960, v12
    v_lshl_add_u64 v[44:45], v[44:45], 0, s[46:47]
    s_mov_b64 exec, s[84:85]
    ds_add_u64 v12, v[42:43]
    ds_add_u64 v12, v[44:45] offset:50000
    s_mov_b64 exec, -1
    s_branch k2_xe_0
k2_xf_0:
    v_and_b32 v12, v6, v96
    v_and_b32 v13, 0xfff8, v96
    v_add_u32 v13, 40960, v13
    v_lshlrev_b32 v42, 16, v50
    v_and_b32 v43, v6, v50
    v_lshlrev_b32 v44, 16, v51
    v_and_b32 v45, v6, v51
    v_mul_f32 v42, v42, v12
    v_mul_f32 v43, v43, v12
    v_mul_f32 v44, v44, v12
    v_mul_f32 v45, v45, v12
    s_mov_b64 exec, s[80:81]
    ds_add_f32 v13, v42
    ds_add_f32 v13, v43 offset:4
    ds_add_f32 v13, v44 offset:50000
    ds_add_f32 v13, v45 offset:50004
    s_mov_b64 exec, -1
    s_waitcnt lgkmcnt(0)
    v_and_b32 v12, v6, v98
    v_and_b32 v13, 0xfff8, v98
    v_add_u32 v13, 40960, v13
    v_lshlrev_b32 v42, 16, v52
    v_and_b32 v43, v6, v52
    v_lshlrev_b32 v44, 16, v53
    v_and_b32 v45, v6, v53
    v_mul_f32 v42, v42, v12
    v_mul_f32 v43, v43, v12
    v_mul_f32 v44, v44, v12
    v_mul_f32 v45, v45, v12
    s_mov_b64 exec, s[82:83]
    ds_add_f32 v13, v42
    ds_add_f32 v13, v43 offset:4
    ds_add_f32 v13, v44 offset:50000
    ds_add_f32 v13, v45 offset:50004
    s_mov_b64 exec, -1
    s_waitcnt lgkmcnt(0)
    v_and_b32 v12, v6, v99
    v_and_b32 v13, 0xfff8, v99
    v_add_u32 v13, 40960, v13
    v_lshlrev_b32 v42, 16, v54
    v_and_b32 v43, v6, v54
    v_lshlrev_b32 v44, 16, v55
    v_and_b32 v45, v6, v55
    v_mul_f32 v42, v42, v12
    v_mul_f32 v43, v43, v12
    v_mul_f32 v44, v44, v12
    v_mul_f32 v45, v45, v12
    s_mov_b64 exec, s[84:85]
    ds_add_f32 v13, v42
    ds_add_f32 v13, v43 offset:4
    ds_add_f32 v13, v44 offset:50000
    ds_add_f32 v13, v45 offset:50004
    s_mov_b64 exec, -1
    s_waitcnt lgkmcnt(0)
    s_branch k2_xe_0
k2_xz_0:
    v_alignbit_b32 v30, v96, v97, 19
    v_lshlrev_b32 v31, 10, v97
    v_and_b32 v30, 0xfff8, v30
    v_lshlrev_b32 v32, 20, v97
    v_alignbit_b32 v31, v98, v31, 19
    v_alignbit_b32 v32, v99, v32, 19
    v_and_b32 v31, 0xfff8, v31
    v_and_b32 v32, 0xfff8, v32
    s_mov_b64 exec, s[80:81]
    ds_read_b64 v[50:51], v30
    s_mov_b64 exec, s[82:83]
    ds_read_b64 v[52:53], v31
    s_mov_b64 exec, s[84:85]
    ds_read_b64 v[54:55], v32
    s_mov_b64 exec, -1
    s_cmp_lg_u32 s37, 0
    s_waitcnt lgkmcnt(0)
    s_cbranch_scc1 k2_wf_x0
    v_and_b32 v12, v6, v96
    v_lshlrev_b32 v42, 16, v50
    v_and_b32 v43, v6, v50
    v_lshlrev_b32 v44, 16, v51
    v_and_b32 v45, v6, v51
    v_fma_f32 v42, v42, v12, v5
    v_fma_f32 v43, v43, v12, v5
    v_fma_f32 v44, v44, v12, v5
    v_fma_f32 v45, v45, v12, v5
    v_and_b32 v12, 0xfff8, v96
    v_lshl_add_u64 v[42:43], v[42:43], 0, s[46:47]
    v_add_u32 v12, 40960, v12
    v_lshl_add_u64 v[44:45], v[44:45], 0, s[46:47]
    s_mov_b64 exec, s[80:81]
    ds_add_u64 v12, v[42:43]
    ds_add_u64 v12, v[44:45] offset:50000
    s_mov_b64 exec, -1
    v_and_b32 v12, v6, v98
    v_lshlrev_b32 v42, 16, v52
    v_and_b32 v43, v6, v52
    v_lshlrev_b32 v44, 16, v53
    v_and_b32 v45, v6, v53
    v_fma_f32 v42, v42, v12, v5
    v_fma_f32 v43, v43, v12, v5
    v_fma_f32 v44, v44, v12, v5
    v_fma_f32 v45, v45, v12, v5
    v_and_b32 v12, 0xfff8, v98
    v_lshl_add_u64 v[42:43], v[42:43], 0, s[46:47]
    v_add_u32 v12, 40960, v12
    v_lshl_add_u64 v[44:45], v[44:45], 0, s[46:47]
    s_mov_b64 exec, s[82:83]
    ds_add_u64 v12, v[42:43]
    ds_add_u64 v12, v[44:45] offset:50000
    s_mov_b64 exec, -1
    v_and_b32 v12, v6, v99
    v_lshlrev_b32 v42, 16, v54
    v_and_b32 v43, v6, v54
    v_lshlrev_b32 v44, 16, v55
    v_and_b32 v45, v6, v55
    v_fma_f32 v42, v42, v12, v5
    v_fma_f32 v43, v43, v12, v5
    v_fma_f32 v44, v44, v12, v5
    v_fma_f32 v45, v45, v12, v5
    v_and_b32 v12, 0xfff8, v99
    v_lshl_add_u64 v[42:43], v[42:43], 0, s[46:47]
    v_add_u32 v12, 40960, v12
    v_lshl_add_u64 v[44:45], v[44:45], 0, s[46:47]
    s_mov_b64 exec, s[84:85]
    ds_add_u64 v12, v[42:43]
    ds_add_u64 v12, v[44:45] offset:50000
    s_mov_b64 exec, -1
    s_branch k2_we_x0
k2_wf_x0:
    v_and_b32 v12, v6, v96
    v_and_b32 v13, 0xfff8, v96
    v_add_u32 v13, 40960, v13
    v_lshlrev_b32 v42, 16, v50
    v_and_b32 v43, v6, v50
    v_lshlrev_b32 v44, 16, v51
    v_and_b32 v45, v6, v51
    v_mul_f32 v42, v42, v12
    v_mul_f32 v43, v43, v12
    v_mul_f32 v44, v44, v12
    v_mul_f32 v45, v45, v12
    s_mov_b64 exec, s[80:81]
    ds_add_f32 v13, v42
    ds_add_f32 v13, v43 offset:4
    ds_add_f32 v13, v44 offset:50000
    ds_add_f32 v13, v45 offset:50004
    s_mov_b64 exec, -1
    s_waitcnt lgkmcnt(0)
    v_and_b32 v12, v6, v98
    v_and_b32 v13, 0xfff8, v98
    v_add_u32 v13, 40960, v13
    v_lshlrev_b32 v42, 16, v52
    v_and_b32 v43, v6, v52
    v_lshlrev_b32 v44, 16, v53
    v_and_b32 v45, v6, v53
    v_mul_f32 v42, v42, v12
    v_mul_f32 v43, v43, v12
    v_mul_f32 v44, v44, v12
    v_mul_f32 v45, v45, v12
    s_mov_b64 exec, s[82:83]
    ds_add_f32 v13, v42
    ds_add_f32 v13, v43 offset:4
    ds_add_f32 v13, v44 offset:50000
    ds_add_f32 v13, v45 offset:50004
    s_mov_b64 exec, -1
    s_waitcnt lgkmcnt(0)
    v_and_b32 v12, v6, v99
    v_and_b32 v13, 0xfff8, v99
    v_add_u32 v13, 40960, v13
    v_lshlrev_b32 v42, 16, v54
    v_and_b32 v43, v6, v54
    v_lshlrev_b32 v44, 16, v55
    v_and_b32 v45, v6, v55
    v_mul_f32 v42, v42, v12
    v_mul_f32 v43, v43, v12
    v_mul_f32 v44, v44, v12
    v_mul_f32 v45, v45, v12
    s_mov_b64 exec, s[84:85]
    ds_add_f32 v13, v42
    ds_add_f32 v13, v43 offset:4
    ds_add_f32 v13, v44 offset:50000
    ds_add_f32 v13, v45 offset:50004
    s_mov_b64 exec, -1
    s_waitcnt lgkmcnt(0)
k2_we_x0:
    s_waitcnt lgkmcnt(0)
    s_cmp_le_u32 s92, 2048
    s_cbranch_scc1 k2_nx_0
    s_movk_i32 s44, 2048
    s_add_u32 s41, s35, 0
    s_call_b64 s[20:21], k2_slow
    s_waitcnt lgkmcnt(0)
    s_set_gpr_idx_on s35, 0x1
    v_mov_b32 v62, v66
    v_mov_b32 v63, v67
    s_set_gpr_idx_off
    v_and_b32 v56, 0x7fff0, v63
    v_and_b32 v58, 0x7fff0, v62
    v_sub_u32 v56, v56, v58
    v_and_b32 v59, 0x7fff3, v62
    v_add_u32 v56, -48, v56
    v_max_i32 v56, 0, v56
    v_mov_b32 v57, v56
    v_add_u32 v59, v59, v2
    v_cmp_ne_u32 s[54:55], 0, v56
    v_add_u32_dpp v57, v57, v57 row_shr:1 row_mask:0xf bank_mask:0xf
    s_nop 1
    v_add_u32_dpp v57, v57, v57 row_shr:2 row_mask:0xf bank_mask:0xf
    s_nop 1
    v_add_u32_dpp v57, v57, v57 row_shr:4 row_mask:0xf bank_mask:0xf
    s_nop 1
    v_add_u32_dpp v57, v57, v57 row_shr:8 row_mask:0xf bank_mask:0xf
    s_nop 1
    v_add_u32_dpp v57, v57, v57 row_bcast:15 row_mask:0xa bank_mask:0xf
    s_nop 1
    v_add_u32_dpp v57, v57, v57 row_bcast:31 row_mask:0xc bank_mask:0xf
    s_nop 1
    v_sub_u32 v58, v57, v56
    v_readlane_b32 s100, v57, 63
    v_sub_u32 v59, v59, v58
    s_branch k2_nx_0
k2_wz_ra0:
    s_waitcnt lgkmcnt(0)
    s_branch k2_w_ra0
k2_accf_r0:
    buffer_load_dword v108, v4, s[12:15], 0 offen offset:0
    buffer_load_dword v109, v4, s[12:15], 0 offen offset:256
    buffer_load_dword v110, v4, s[12:15], 0 offen offset:512
    buffer_load_dword v111, v4, s[12:15], 0 offen offset:768
    v_and_b32 v12, v6, v88
    v_and_b32 v13, 0xfff8, v88
    v_add_u32 v13, 40960, v13
    v_lshlrev_b32 v42, 16, v24
    v_and_b32 v43, v6, v24
    v_lshlrev_b32 v44, 16, v25
    v_and_b32 v45, v6, v25
    v_mul_f32 v42, v42, v12
    v_mul_f32 v43, v43, v12
    v_mul_f32 v44, v44, v12
    v_mul_f32 v45, v45, v12
    s_mov_b64 exec, s[56:57]
    ds_add_f32 v13, v42
    ds_add_f32 v13, v43 offset:4
    ds_add_f32 v13, v44 offset:50000
    ds_add_f32 v13, v45 offset:50004
    s_mov_b64 exec, -1
    s_waitcnt lgkmcnt(0)
    v_and_b32 v12, v6, v90
    v_and_b32 v13, 0xfff8, v90
    v_add_u32 v13, 40960, v13
    v_lshlrev_b32 v42, 16, v26
    v_and_b32 v43, v6, v26
    v_lshlrev_b32 v44, 16, v27
    v_and_b32 v45, v6, v27
    v_mul_f32 v42, v42, v12
    v_mul_f32 v43, v43, v12
    v_mul_f32 v44, v44, v12
    v_mul_f32 v45, v45, v12
    s_mov_b64 exec, s[58:59]
    ds_add_f32 v13, v42
    ds_add_f32 v13, v43 offset:4
    ds_add_f32 v13, v44 offset:50000
    ds_add_f32 v13, v45 offset:50004
    s_mov_b64 exec, -1
    s_waitcnt lgkmcnt(0)
    v_and_b32 v12, v6, v91
    v_and_b32 v13, 0xfff8, v91
    v_add_u32 v13, 40960, v13
    v_lshlrev_b32 v42, 16, v28
    v_and_b32 v43, v6, v28
    v_lshlrev_b32 v44, 16, v29
    v_and_b32 v45, v6, v29
    v_mul_f32 v42, v42, v12
    v_mul_f32 v43, v43, v12
    v_mul_f32 v44, v44, v12
    v_mul_f32 v45, v45, v12
    s_mov_b64 exec, s[60:61]
    ds_add_f32 v13, v42
    ds_add_f32 v13, v43 offset:4
    ds_add_f32 v13, v44 offset:50000
    ds_add_f32 v13, v45 offset:50004
    s_mov_b64 exec, -1
    s_waitcnt lgkmcnt(0)
    s_mov_b64 s[56:57], 0
    s_mov_b64 s[58:59], 0
    s_mov_b64 s[60:61], 0
    s_branch k2_acce_r0
k2_sy_l0:
    s_movk_i32 s44, 1024
    s_add_u32 s40, s44, 1024
    v_cmp_ge_u32 s[48:49], s44, v58
    v_subrev_u32 v60, s44, v58
    v_cmp_eq_u32 s[52:53], s40, v57
    s_bcnt1_i32_b64 s39, s[48:49]
    v_add_u32 v61, -16, v60
    s_sub_u32 s39, s39, 1
    v_cmp_gt_u32 vcc, 1008, v61
    v_readlane_b32 s42, v59, s39
    v_lshrrev_b32 v60, 2, v60
    s_and_b64 s[50:51], vcc, s[54:55]
    v_cndmask_b32 v60, 0, v60, s[50:51]
    v_cndmask_b32 v61, 0, v59, s[50:51]
    ds_permute_b32 v61, v60, v61
    s_waitcnt lgkmcnt(0)
    v_cmp_ne_u32 s[48:49], 0, v61
    v_add_u32 v60, s44, v1
    s_cmp_lg_u64 s[52:53], 0
    v_max_u32_dpp v61, v61, v61 row_shr:1 row_mask:0xf bank_mask:0xf
    v_cmp_gt_u32 s[80:81], s92, v60
    s_cselect_b32 s53, 0x80000000, 0
    v_max_u32_dpp v61, v61, v61 row_shr:2 row_mask:0xf bank_mask:0xf
    s_mov_b32 s52, 0
    s_lshr_b64 s[48:49], s[48:49], 1
    v_max_u32_dpp v61, v61, v61 row_shr:4 row_mask:0xf bank_mask:0xf
    s_or_b64 s[52:53], s[52:53], s[48:49]
    s_lshr_b64 s[48:49], s[80:81], 1
    v_max_u32_dpp v61, v61, v61 row_shr:8 row_mask:0xf bank_mask:0xf
    s_andn2_b64 s[48:49], s[80:81], s[48:49]
    s_bitset0_b64 s[48:49], 63
    v_max_u32_dpp v61, v61, v61 row_bcast:15 row_mask:0xa bank_mask:0xf
    s_or_b64 s[52:53], s[52:53], s[48:49]
    s_nop 0
    v_max_u32_dpp v61, v61, v61 row_bcast:31 row_mask:0xc bank_mask:0xf
    v_max_u32 v61, s42, v61
    v_add_u32 v60, v60, v61
    v_and_b32 v61, 3, v61
    v_and_b32 v60, -16, v60
    v_cmp_eq_u32 s[48:49], 2, v61
    v_cmp_ne_u32 s[50:51], 0, v61
    v_cndmask_b32 v60, v6, v60, s[80:81]
    buffer_load_dwordx4 v[96:99], v60, s[4:7], 0 offen
    s_and_b64 s[48:49], s[48:49], s[52:53]
    s_and_b64 s[50:51], s[50:51], s[52:53]
    s_andn2_b64 s[82:83], s[80:81], s[48:49]
    s_andn2_b64 s[84:85], s[80:81], s[50:51]
    s_branch k2_ns_l0
k2_wz_rb0:
    s_waitcnt lgkmcnt(0)
    s_branch k2_w_rb0
k2_xy_1:
    s_cmp_gt_u32 s93, 2048
    s_cbranch_scc1 k2_xz_1
    v_alignbit_b32 v30, v100, v101, 19
    v_lshlrev_b32 v31, 10, v101
    v_and_b32 v30, 0xfff8, v30
    v_lshlrev_b32 v32, 20, v101
    v_alignbit_b32 v31, v102, v31, 19
    v_alignbit_b32 v32, v103, v32, 19
    v_and_b32 v31, 0xfff8, v31
    v_and_b32 v32, 0xfff8, v32
    s_mov_b64 exec, s[86:87]
    ds_read_b64 v[50:51], v30
    s_mov_b64 exec, s[88:89]
    ds_read_b64 v[52:53], v31
    s_mov_b64 exec, s[90:91]
    ds_read_b64 v[54:55], v32
    s_mov_b64 exec, -1
    s_mov_b32 s94, 1
    s_branch k2_nx_1
k2_xb_1:
    s_mov_b32 s94, 0
    s_cmp_lg_u32 s37, 0
    s_cbranch_scc1 k2_xf_1
    v_and_b32 v12, v6, v100
    v_lshlrev_b32 v42, 16, v50
    v_and_b32 v43, v6, v50
    v_lshlrev_b32 v44, 16, v51
    v_and_b32 v45, v6, v51
    v_fma_f32 v42, v42, v12, v5
    v_fma_f32 v43, v43, v12, v5
    v_fma_f32 v44, v44, v12, v5
    v_fma_f32 v45, v45, v12, v5
    v_and_b32 v12, 0xfff8, v100
    v_lshl_add_u64 v[42:43], v[42:43], 0, s[46:47]
    v_add_u32 v12, 40960, v12
    v_lshl_add_u64 v[44:45], v[44:45], 0, s[46:47]
    s_mov_b64 exec, s[86:87]
    ds_add_u64 v12, v[42:43]
    ds_add_u64 v12, v[44:45] offset:50000
    s_mov_b64 exec, -1
    v_and_b32 v12, v6, v102
    v_lshlrev_b32 v42, 16, v52
    v_and_b32 v43, v6, v52
    v_lshlrev_b32 v44, 16, v53
    v_and_b32 v45, v6, v53
    v_fma_f32 v42, v42, v12, v5
    v_fma_f32 v43, v43, v12, v5
    v_fma_f32 v44, v44, v12, v5
    v_fma_f32 v45, v45, v12, v5
    v_and_b32 v12, 0xfff8, v102
    v_lshl_add_u64 v[42:43], v[42:43], 0, s[46:47]
    v_add_u32 v12, 40960, v12
    v_lshl_add_u64 v[44:45], v[44:45], 0, s[46:47]
    s_mov_b64 exec, s[88:89]
    ds_add_u64 v12, v[42:43]
    ds_add_u64 v12, v[44:45] offset:50000
    s_mov_b64 exec, -1
    v_and_b32 v12, v6, v103
    v_lshlrev_b32 v42, 16, v54
    v_and_b32 v43, v6, v54
    v_lshlrev_b32 v44, 16, v55
    v_and_b32 v45, v6, v55
    v_fma_f32 v42, v42, v12, v5
    v_fma_f32 v43, v43, v12, v5
    v_fma_f32 v44, v44, v12, v5
    v_fma_f32 v45, v45, v12, v5
    v_and_b32 v12, 0xfff8, v103
    v_lshl_add_u64 v[42:43], v[42:43], 0, s[46:47]
    v_add_u32 v12, 40960, v12
    v_lshl_add_u64 v[44:45], v[44:45], 0, s[46:47]
    s_mov_b64 exec, s[90:91]
    ds_add_u64 v12, v[42:43]
    ds_add_u64 v12, v[44:45] offset:50000
    s_mov_b64 exec, -1
    s_branch k2_xe_1
k2_xf_1:
    v_and_b32 v12, v6, v100
    v_and_b32 v13, 0xfff8, v100
    v_add_u32 v13, 40960, v13
    v_lshlrev_b32 v42, 16, v50
    v_and_b32 v43, v6, v50
    v_lshlrev_b32 v44, 16, v51
    v_and_b32 v45, v6, v51
    v_mul_f32 v42, v42, v12
    v_mul_f32 v43, v43, v12
    v_mul_f32 v44, v44, v12
    v_mul_f32 v45, v45, v12
    s_mov_b64 exec, s[86:87]
    ds_add_f32 v13, v42
    ds_add_f32 v13, v43 offset:4
    ds_add_f32 v13, v44 offset:50000
    ds_add_f32 v13, v45 offset:50004
    s_mov_b64 exec, -1
    s_waitcnt lgkmcnt(0)
    v_and_b32 v12, v6, v102
    v_and_b32 v13, 0xfff8, v102
    v_add_u32 v13, 40960, v13
    v_lshlrev_b32 v42, 16, v52
    v_and_b32 v43, v6, v52
    v_lshlrev_b32 v44, 16, v53
    v_and_b32 v45, v6, v53
    v_mul_f32 v42, v42, v12
    v_mul_f32 v43, v43, v12
    v_mul_f32 v44, v44, v12
    v_mul_f32 v45, v45, v12
    s_mov_b64 exec, s[88:89]
    ds_add_f32 v13, v42
    ds_add_f32 v13, v43 offset:4
    ds_add_f32 v13, v44 offset:50000
    ds_add_f32 v13, v45 offset:50004
    s_mov_b64 exec, -1
    s_waitcnt lgkmcnt(0)
    v_and_b32 v12, v6, v103
    v_and_b32 v13, 0xfff8, v103
    v_add_u32 v13, 40960, v13
    v_lshlrev_b32 v42, 16, v54
    v_and_b32 v43, v6, v54
    v_lshlrev_b32 v44, 16, v55
    v_and_b32 v45, v6, v55
    v_mul_f32 v42, v42, v12
    v_mul_f32 v43, v43, v12
    v_mul_f32 v44, v44, v12
    v_mul_f32 v45, v45, v12
    s_mov_b64 exec, s[90:91]
    ds_add_f32 v13, v42
    ds_add_f32 v13, v43 offset:4
    ds_add_f32 v13, v44 offset:50000
    ds_add_f32 v13, v45 offset:50004
    s_mov_b64 exec, -1
    s_waitcnt lgkmcnt(0)
    s_branch k2_xe_1
k2_xz_1:
    v_alignbit_b32 v30, v100, v101, 19
    v_lshlrev_b32 v31, 10, v101
    v_and_b32 v30, 0xfff8, v30
    v_lshlrev_b32 v32, 20, v101
    v_alignbit_b32 v31, v102, v31, 19
    v_alignbit_b32 v32, v103, v32, 19
    v_and_b32 v31, 0xfff8, v31
    v_and_b32 v32, 0xfff8, v32
    s_mov_b64 exec, s[86:87]
    ds_read_b64 v[50:51], v30
    s_mov_b64 exec, s[88:89]
    ds_read_b64 v[52:53], v31
    s_mov_b64 exec, s[90:91]
    ds_read_b64 v[54:55], v32
    s_mov_b64 exec, -1
    s_cmp_lg_u32 s37, 0
    s_waitcnt lgkmcnt(0)
    s_cbranch_scc1 k2_wf_x1
    v_and_b32 v12, v6, v100
    v_lshlrev_b32 v42, 16, v50
    v_and_b32 v43, v6, v50
    v_lshlrev_b32 v44, 16, v51
    v_and_b32 v45, v6, v51
    v_fma_f32 v42, v42, v12, v5
    v_fma_f32 v43, v43, v12, v5
    v_fma_f32 v44, v44, v12, v5
    v_fma_f32 v45, v45, v12, v5
    v_and_b32 v12, 0xfff8, v100
    v_lshl_add_u64 v[42:43], v[42:43], 0, s[46:47]
    v_add_u32 v12, 40960, v12
    v_lshl_add_u64 v[44:45], v[44:45], 0, s[46:47]
    s_mov_b64 exec, s[86:87]
    ds_add_u64 v12, v[42:43]
    ds_add_u64 v12, v[44:45] offset:50000
    s_mov_b64 exec, -1
    v_and_b32 v12, v6, v102
    v_lshlrev_b32 v42, 16, v52
    v_and_b32 v43, v6, v52
    v_lshlrev_b32 v44, 16, v53
    v_and_b32 v45, v6, v53
    v_fma_f32 v42, v42, v12, v5
    v_fma_f32 v43, v43, v12, v5
    v_fma_f32 v44, v44, v12, v5
    v_fma_f32 v45, v45, v12, v5
    v_and_b32 v12, 0xfff8, v102
    v_lshl_add_u64 v[42:43], v[42:43], 0, s[46:47]
    v_add_u32 v12, 40960, v12
    v_lshl_add_u64 v[44:45], v[44:45], 0, s[46:47]
    s_mov_b64 exec, s[88:89]
    ds_add_u64 v12, v[42:43]
    ds_add_u64 v12, v[44:45] offset:50000
    s_mov_b64 exec, -1
    v_and_b32 v12, v6, v103
    v_lshlrev_b32 v42, 16, v54
    v_and_b32 v43, v6, v54
    v_lshlrev_b32 v44, 16, v55
    v_and_b32 v45, v6, v55
    v_fma_f32 v42, v42, v12, v5
    v_fma_f32 v43, v43, v12, v5
    v_fma_f32 v44, v44, v12, v5
    v_fma_f32 v45, v45, v12, v5
    v_and_b32 v12, 0xfff8, v103
    v_lshl_add_u64 v[42:43], v[42:43], 0, s[46:47]
    v_add_u32 v12, 40960, v12
    v_lshl_add_u64 v[44:45], v[44:45], 0, s[46:47]
    s_mov_b64 exec, s[90:91]
    ds_add_u64 v12, v[42:43]
    ds_add_u64 v12, v[44:45] offset:50000
    s_mov_b64 exec, -1
    s_branch k2_we_x1
k2_wf_x1:
    v_and_b32 v12, v6, v100
    v_and_b32 v13, 0xfff8, v100
    v_add_u32 v13, 40960, v13
    v_lshlrev_b32 v42, 16, v50
    v_and_b32 v43, v6, v50
    v_lshlrev_b32 v44, 16, v51
    v_and_b32 v45, v6, v51
    v_mul_f32 v42, v42, v12
    v_mul_f32 v43, v43, v12
    v_mul_f32 v44, v44, v12
    v_mul_f32 v45, v45, v12
    s_mov_b64 exec, s[86:87]
    ds_add_f32 v13, v42
    ds_add_f32 v13, v43 offset:4
    ds_add_f32 v13, v44 offset:50000
    ds_add_f32 v13, v45 offset:50004
    s_mov_b64 exec, -1
    s_waitcnt lgkmcnt(0)
    v_and_b32 v12, v6, v102
    v_and_b32 v13, 0xfff8, v102
    v_add_u32 v13, 40960, v13
    v_lshlrev_b32 v42, 16, v52
    v_and_b32 v43, v6, v52
    v_lshlrev_b32 v44, 16, v53
    v_and_b32 v45, v6, v53
    v_mul_f32 v42, v42, v12
    v_mul_f32 v43, v43, v12
    v_mul_f32 v44, v44, v12
    v_mul_f32 v45, v45, v12
    s_mov_b64 exec, s[88:89]
    ds_add_f32 v13, v42
    ds_add_f32 v13, v43 offset:4
    ds_add_f32 v13, v44 offset:50000
    ds_add_f32 v13, v45 offset:50004
    s_mov_b64 exec, -1
    s_waitcnt lgkmcnt(0)
    v_and_b32 v12, v6, v103
    v_and_b32 v13, 0xfff8, v103
    v_add_u32 v13, 40960, v13
    v_lshlrev_b32 v42, 16, v54
    v_and_b32 v43, v6, v54
    v_lshlrev_b32 v44, 16, v55
    v_and_b32 v45, v6, v55
    v_mul_f32 v42, v42, v12
    v_mul_f32 v43, v43, v12
    v_mul_f32 v44, v44, v12
    v_mul_f32 v45, v45, v12
    s_mov_b64 exec, s[90:91]
    ds_add_f32 v13, v42
    ds_add_f32 v13, v43 offset:4
    ds_add_f32 v13, v44 offset:50000
    ds_add_f32 v13, v45 offset:50004
    s_mov_b64 exec, -1
    s_waitcnt lgkmcnt(0)
k2_we_x1:
    s_waitcnt lgkmcnt(0)
    s_cmp_le_u32 s93, 2048
    s_cbranch_scc1 k2_nx_1
    s_movk_i32 s44, 2048
    s_add_u32 s41, s35, 1
    s_call_b64 s[20:21], k2_slow
    s_waitcnt lgkmcnt(0)
    s_set_gpr_idx_on s35, 0x1
    v_mov_b32 v62, v67
    v_mov_b32 v63, v68
    s_set_gpr_idx_off
    v_and_b32 v56, 0x7fff0, v63
    v_and_b32 v58, 0x7fff0, v62
    v_sub_u32 v56, v56, v58
    v_and_b32 v59, 0x7fff3, v62
    v_add_u32 v56, -48, v56
    v_max_i32 v56, 0, v56
    v_mov_b32 v57, v56
    v_add_u32 v59, v59, v2
    v_cmp_ne_u32 s[54:55], 0, v56
    v_add_u32_dpp v57, v57, v57 row_shr:1 row_mask:0xf bank_mask:0xf
    s_nop 1
    v_add_u32_dpp v57, v57, v57 row_shr:2 row_mask:0xf bank_mask:0xf
    s_nop 1
    v_add_u32_dpp v57, v57, v57 row_shr:4 row_mask:0xf bank_mask:0xf
    s_nop 1
    v_add_u32_dpp v57, v57, v57 row_shr:8 row_mask:0xf bank_mask:0xf
    s_nop 1
    v_add_u32_dpp v57, v57, v57 row_bcast:15 row_mask:0xa bank_mask:0xf
    s_nop 1
    v_add_u32_dpp v57, v57, v57 row_bcast:31 row_mask:0xc bank_mask:0xf
    s_nop 1
    v_sub_u32 v58, v57, v56
    v_readlane_b32 s100, v57, 63
    v_sub_u32 v59, v59, v58
    s_branch k2_nx_1
k2_wz_ra1:
    s_waitcnt lgkmcnt(0)
    s_branch k2_w_ra1
k2_accf_r1:
    buffer_load_dword v14, v4, s[12:15], 0 offen offset:0
    buffer_load_dword v15, v4, s[12:15], 0 offen offset:256
    buffer_load_dword v16, v4, s[12:15], 0 offen offset:512
    buffer_load_dword v17, v4, s[12:15], 0 offen offset:768
    v_and_b32 v12, v6, v92
    v_and_b32 v13, 0xfff8, v92
    v_add_u32 v13, 40960, v13
    v_lshlrev_b32 v42, 16, v24
    v_and_b32 v43, v6, v24
    v_lshlrev_b32 v44, 16, v25
    v_and_b32 v45, v6, v25
    v_mul_f32 v42, v42, v12
    v_mul_f32 v43, v43, v12
    v_mul_f32 v44, v44, v12
    v_mul_f32 v45, v45, v12
    s_mov_b64 exec, s[62:63]
    ds_add_f32 v13, v42
    ds_add_f32 v13, v43 offset:4
    ds_add_f32 v13, v44 offset:50000
    ds_add_f32 v13, v45 offset:50004
    s_mov_b64 exec, -1
    s_waitcnt lgkmcnt(0)
    v_and_b32 v12, v6, v94
    v_and_b32 v13, 0xfff8, v94
    v_add_u32 v13, 40960, v13
    v_lshlrev_b32 v42, 16, v26
    v_and_b32 v43, v6, v26
    v_lshlrev_b32 v44, 16, v27
    v_and_b32 v45, v6, v27
    v_mul_f32 v42, v42, v12
    v_mul_f32 v43, v43, v12
    v_mul_f32 v44, v44, v12
    v_mul_f32 v45, v45, v12
    s_mov_b64 exec, s[64:65]
    ds_add_f32 v13, v42
    ds_add_f32 v13, v43 offset:4
    ds_add_f32 v13, v44 offset:50000
    ds_add_f32 v13, v45 offset:50004
    s_mov_b64 exec, -1
    s_waitcnt lgkmcnt(0)
    v_and_b32 v12, v6, v95
    v_and_b32 v13, 0xfff8, v95
    v_add_u32 v13, 40960, v13
    v_lshlrev_b32 v42, 16, v104
    v_and_b32 v43, v6, v104
    v_lshlrev_b32 v44, 16, v105
    v_and_b32 v45, v6, v105
    v_mul_f32 v42, v42, v12
    v_mul_f32 v43, v43, v12
    v_mul_f32 v44, v44, v12
    v_mul_f32 v45, v45, v12
    s_mov_b64 exec, s[66:67]
    ds_add_f32 v13, v42
    ds_add_f32 v13, v43 offset:4
    ds_add_f32 v13, v44 offset:50000
    ds_add_f32 v13, v45 offset:50004
    s_mov_b64 exec, -1
    s_waitcnt lgkmcnt(0)
    s_mov_b64 s[62:63], 0
    s_mov_b64 s[64:65], 0
    s_mov_b64 s[66:67], 0
    s_branch k2_acce_r1
k2_ey_r:
    buffer_load_dword v122, v122, s[16:19], 0 offen
    buffer_load_dwordx4 v[124:127], v121, s[8:11], 0 offen
    s_branch k2_en_r
k2_sy_l1:
    s_movk_i32 s44, 1024
    s_add_u32 s40, s44, 1024
    v_cmp_ge_u32 s[48:49], s44, v58
    v_subrev_u32 v60, s44, v58
    v_cmp_eq_u32 s[52:53], s40, v57
    s_bcnt1_i32_b64 s39, s[48:49]
    v_add_u32 v61, -16, v60
    s_sub_u32 s39, s39, 1
    v_cmp_gt_u32 vcc, 1008, v61
    v_readlane_b32 s42, v59, s39
    v_lshrrev_b32 v60, 2, v60
    s_and_b64 s[50:51], vcc, s[54:55]
    v_cndmask_b32 v60, 0, v60, s[50:51]
    v_cndmask_b32 v61, 0, v59, s[50:51]
    ds_permute_b32 v61, v60, v61
    s_waitcnt lgkmcnt(0)
    v_cmp_ne_u32 s[48:49], 0, v61
    v_add_u32 v60, s44, v1
    s_cmp_lg_u64 s[52:53], 0
    v_max_u32_dpp v61, v61, v61 row_shr:1 row_mask:0xf bank_mask:0xf
    v_cmp_gt_u32 s[86:87], s93, v60
    s_cselect_b32 s53, 0x80000000, 0
    v_max_u32_dpp v61, v61, v61 row_shr:2 row_mask:0xf bank_mask:0xf
    s_mov_b32 s52, 0
    s_lshr_b64 s[48:49], s[48:49], 1
    v_max_u32_dpp v61, v61, v61 row_shr:4 row_mask:0xf bank_mask:0xf
    s_or_b64 s[52:53], s[52:53], s[48:49]
    s_lshr_b64 s[48:49], s[86:87], 1
    v_max_u32_dpp v61, v61, v61 row_shr:8 row_mask:0xf bank_mask:0xf
    s_andn2_b64 s[48:49], s[86:87], s[48:49]
    s_bitset0_b64 s[48:49], 63
    v_max_u32_dpp v61, v61, v61 row_bcast:15 row_mask:0xa bank_mask:0xf
    s_or_b64 s[52:53], s[52:53], s[48:49]
    s_nop 0
    v_max_u32_dpp v61, v61, v61 row_bcast:31 row_mask:0xc bank_mask:0xf
    v_max_u32 v61, s42, v61
    v_add_u32 v60, v60, v61
    v_and_b32 v61, 3, v61
    v_and_b32 v60, -16, v60
    v_cmp_eq_u32 s[48:49], 2, v61
    v_cmp_ne_u32 s[50:51], 0, v61
    v_cndmask_b32 v60, v6, v60, s[86:87]
    buffer_load_dwordx4 v[100:103], v60, s[4:7], 0 offen
    s_and_b64 s[48:49], s[48:49], s[52:53]
    s_and_b64 s[50:51], s[50:51], s[52:53]
    s_andn2_b64 s[88:89], s[86:87], s[48:49]
    s_andn2_b64 s[90:91], s[86:87], s[50:51]
    s_branch k2_ns_l1
k2_wz_rb1:
    s_waitcnt lgkmcnt(0)
    s_branch k2_w_rb1
k2_epf:
    s_lshl_b32 s39, s35, 1
    s_add_u32 s16, s22, s39
    s_addc_u32 s17, s23, 0
    s_add_u32 s16, s16, 104857600
    s_addc_u32 s17, s17, 0
    s_mov_b32 s18, 100000
    s_mov_b32 s19, 0x00020000
    v_lshlrev_b32 v42, 1, v42
    buffer_store_dwordx2 v[64:65], v42, s[16:19], 0 offen sc1
    buffer_store_dwordx2 v[68:69], v42, s[16:19], 0 offen offset:8 sc1
    buffer_store_dwordx2 v[66:67], v42, s[16:19], 0 offen offset:16 sc1
    buffer_store_dwordx2 v[70:71], v42, s[16:19], 0 offen offset:24 sc1
    v_lshlrev_b32 v43, 1, v43
    buffer_store_dwordx2 v[72:73], v43, s[16:19], 0 offen sc1
    buffer_store_dwordx2 v[76:77], v43, s[16:19], 0 offen offset:8 sc1
    buffer_store_dwordx2 v[74:75], v43, s[16:19], 0 offen offset:16 sc1
    buffer_store_dwordx2 v[78:79], v43, s[16:19], 0 offen offset:24 sc1
    v_lshlrev_b32 v44, 1, v44
    buffer_store_dwordx2 v[80:81], v44, s[16:19], 0 offen sc1
    buffer_store_dwordx2 v[84:85], v44, s[16:19], 0 offen offset:8 sc1
    buffer_store_dwordx2 v[82:83], v44, s[16:19], 0 offen offset:16 sc1
    buffer_store_dwordx2 v[86:87], v44, s[16:19], 0 offen offset:24 sc1
    s_waitcnt vmcnt(0)
    s_branch k2_epj
k2_fslow:
    s_add_u32 s4, s22, 104857600
    s_addc_u32 s5, s23, 0
    s_mov_b32 s6, 25600000
    s_mov_b32 s7, 0x00020000
    v_mov_b32 v16, v88
    v_mov_b32 v17, v89
    v_mov_b32 v18, v92
    v_mov_b32 v19, v93
    v_mov_b32 v20, v90
    v_mov_b32 v21, v91
    v_mov_b32 v22, v94
    v_mov_b32 v23, v95
    s_waitcnt vmcnt(0)
    s_add_u32 s39, s34, 1
    s_and_b32 s39, s39, 3
    s_add_u32 s39, s39, 8
    s_bitcmp1_b32 s45, s39
    s_cbranch_scc1 k2_s32_0
    v_fma_mix_f32 v16, v96, v9, v16 op_sel:[0,0,0] op_sel_hi:[1,0,0]
    v_fma_mix_f32 v17, v96, v9, v17 op_sel:[1,0,0] op_sel_hi:[1,0,0]
    v_fma_mix_f32 v18, v97, v9, v18 op_sel:[0,0,0] op_sel_hi:[1,0,0]
    v_fma_mix_f32 v19, v97, v9, v19 op_sel:[1,0,0] op_sel_hi:[1,0,0]
    v_fma_mix_f32 v20, v98, v9, v20 op_sel:[0,0,0] op_sel_hi:[1,0,0]
    v_fma_mix_f32 v21, v98, v9, v21 op_sel:[1,0,0] op_sel_hi:[1,0,0]
    v_fma_mix_f32 v22, v99, v9, v22 op_sel:[0,0,0] op_sel_hi:[1,0,0]
    v_fma_mix_f32 v23, v99, v9, v23 op_sel:[1,0,0] op_sel_hi:[1,0,0]
    s_branch k2_sn_0
k2_s32_0:
    v_lshlrev_b32 v56, 1, v56
    buffer_load_dwordx4 v[24:27], v56, s[4:7], 0 offen sc1
    buffer_load_dwordx4 v[28:31], v56, s[4:7], 0 offen offset:16 sc1
    s_waitcnt vmcnt(0)
    v_add_f32 v16, v16, v24
    v_add_f32 v17, v17, v25
    v_add_f32 v18, v18, v26
    v_add_f32 v19, v19, v27
    v_add_f32 v20, v20, v28
    v_add_f32 v21, v21, v29
    v_add_f32 v22, v22, v30
    v_add_f32 v23, v23, v31
k2_sn_0:
    s_add_u32 s39, s34, 2
    s_and_b32 s39, s39, 3
    s_add_u32 s39, s39, 8
    s_bitcmp1_b32 s45, s39
    s_cbranch_scc1 k2_s32_1
    v_fma_mix_f32 v16, v100, v9, v16 op_sel:[0,0,0] op_sel_hi:[1,0,0]
    v_fma_mix_f32 v17, v100, v9, v17 op_sel:[1,0,0] op_sel_hi:[1,0,0]
    v_fma_mix_f32 v18, v101, v9, v18 op_sel:[0,0,0] op_sel_hi:[1,0,0]
    v_fma_mix_f32 v19, v101, v9, v19 op_sel:[1,0,0] op_sel_hi:[1,0,0]
    v_fma_mix_f32 v20, v102, v9, v20 op_sel:[0,0,0] op_sel_hi:[1,0,0]
    v_fma_mix_f32 v21, v102, v9, v21 op_sel:[1,0,0] op_sel_hi:[1,0,0]
    v_fma_mix_f32 v22, v103, v9, v22 op_sel:[0,0,0] op_sel_hi:[1,0,0]
    v_fma_mix_f32 v23, v103, v9, v23 op_sel:[1,0,0] op_sel_hi:[1,0,0]
    s_branch k2_sn_1
k2_s32_1:
    v_lshlrev_b32 v57, 1, v57
    buffer_load_dwordx4 v[24:27], v57, s[4:7], 0 offen sc1
    buffer_load_dwordx4 v[28:31], v57, s[4:7], 0 offen offset:16 sc1
    s_waitcnt vmcnt(0)
    v_add_f32 v16, v16, v24
    v_add_f32 v17, v17, v25
    v_add_f32 v18, v18, v26
    v_add_f32 v19, v19, v27
    v_add_f32 v20, v20, v28
    v_add_f32 v21, v21, v29
    v_add_f32 v22, v22, v30
    v_add_f32 v23, v23, v31
k2_sn_1:
    s_add_u32 s39, s34, 3
    s_and_b32 s39, s39, 3
    s_add_u32 s39, s39, 8
    s_bitcmp1_b32 s45, s39
    s_cbranch_scc1 k2_s32_2
    v_fma_mix_f32 v16, v104, v9, v16 op_sel:[0,0,0] op_sel_hi:[1,0,0]
    v_fma_mix_f32 v17, v104, v9, v17 op_sel:[1,0,0] op_sel_hi:[1,0,0]
    v_fma_mix_f32 v18, v105, v9, v18 op_sel:[0,0,0] op_sel_hi:[1,0,0]
    v_fma_mix_f32 v19, v105, v9, v19 op_sel:[1,0,0] op_sel_hi:[1,0,0]
    v_fma_mix_f32 v20, v106, v9, v20 op_sel:[0,0,0] op_sel_hi:[1,0,0]
    v_fma_mix_f32 v21, v106, v9, v21 op_sel:[1,0,0] op_sel_hi:[1,0,0]
    v_fma_mix_f32 v22, v107, v9, v22 op_sel:[0,0,0] op_sel_hi:[1,0,0]
    v_fma_mix_f32 v23, v107, v9, v23 op_sel:[1,0,0] op_sel_hi:[1,0,0]
    s_branch k2_sn_2
k2_s32_2:
    v_lshlrev_b32 v58, 1, v58
    buffer_load_dwordx4 v[24:27], v58, s[4:7], 0 offen sc1
    buffer_load_dwordx4 v[28:31], v58, s[4:7], 0 offen offset:16 sc1
    s_waitcnt vmcnt(0)
    v_add_f32 v16, v16, v24
    v_add_f32 v17, v17, v25
    v_add_f32 v18, v18, v26
    v_add_f32 v19, v19, v27
    v_add_f32 v20, v20, v28
    v_add_f32 v21, v21, v29
    v_add_f32 v22, v22, v30
    v_add_f32 v23, v23, v31
k2_sn_2:
    s_branch k2_fjoin
k2_slow:
    s_set_gpr_idx_on s41, 0x1
    v_mov_b32 v62, v64
    v_mov_b32 v63, v65
    s_set_gpr_idx_off
    v_and_b32 v56, 0x7fff0, v63
    v_and_b32 v58, 0x7fff0, v62
    v_sub_u32 v56, v56, v58
    v_and_b32 v59, 0x7fff3, v62
    v_add_u32 v56, -48, v56
    v_max_i32 v56, 0, v56
    v_mov_b32 v57, v56
    v_add_u32 v59, v59, v2
    v_cmp_ne_u32 s[54:55], 0, v56
    v_add_u32_dpp v57, v57, v57 row_shr:1 row_mask:0xf bank_mask:0xf
    s_nop 1
    v_add_u32_dpp v57, v57, v57 row_shr:2 row_mask:0xf bank_mask:0xf
    s_nop 1
    v_add_u32_dpp v57, v57, v57 row_shr:4 row_mask:0xf bank_mask:0xf
    s_nop 1
    v_add_u32_dpp v57, v57, v57 row_shr:8 row_mask:0xf bank_mask:0xf
    s_nop 1
    v_add_u32_dpp v57, v57, v57 row_bcast:15 row_mask:0xa bank_mask:0xf
    s_nop 1
    v_add_u32_dpp v57, v57, v57 row_bcast:31 row_mask:0xc bank_mask:0xf
    s_nop 1
    v_sub_u32 v58, v57, v56
    v_readlane_b32 s43, v57, 63
    v_sub_u32 v59, v59, v58
k2_slow_l:
    s_add_u32 s40, s44, 1024
    v_cmp_ge_u32 s[48:49], s44, v58
    v_subrev_u32 v60, s44, v58
    v_cmp_eq_u32 s[52:53], s40, v57
    s_bcnt1_i32_b64 s39, s[48:49]
    v_add_u32 v61, -16, v60
    s_sub_u32 s39, s39, 1
    v_cmp_gt_u32 vcc, 1008, v61
    v_readlane_b32 s42, v59, s39
    v_lshrrev_b32 v60, 2, v60
    s_and_b64 s[50:51], vcc, s[54:55]
    v_cndmask_b32 v60, 0, v60, s[50:51]
    v_cndmask_b32 v61, 0, v59, s[50:51]
    ds_permute_b32 v61, v60, v61
    s_waitcnt lgkmcnt(0)
    v_cmp_ne_u32 s[48:49], 0, v61
    v_add_u32 v60, s44, v1
    s_cmp_lg_u64 s[52:53], 0
    v_max_u32_dpp v61, v61, v61 row_shr:1 row_mask:0xf bank_mask:0xf
    v_cmp_gt_u32 s[24:25], s43, v60
    s_cselect_b32 s53, 0x80000000, 0
    v_max_u32_dpp v61, v61, v61 row_shr:2 row_mask:0xf bank_mask:0xf
    s_mov_b32 s52, 0
    s_lshr_b64 s[48:49], s[48:49], 1
    v_max_u32_dpp v61, v61, v61 row_shr:4 row_mask:0xf bank_mask:0xf
    s_or_b64 s[52:53], s[52:53], s[48:49]
    s_lshr_b64 s[48:49], s[24:25], 1
    v_max_u32_dpp v61, v61, v61 row_shr:8 row_mask:0xf bank_mask:0xf
    s_andn2_b64 s[48:49], s[24:25], s[48:49]
    s_bitset0_b64 s[48:49], 63
    v_max_u32_dpp v61, v61, v61 row_bcast:15 row_mask:0xa bank_mask:0xf
    s_or_b64 s[52:53], s[52:53], s[48:49]
    s_nop 0
    v_max_u32_dpp v61, v61, v61 row_bcast:31 row_mask:0xc bank_mask:0xf
    v_max_u32 v61, s42, v61
    v_add_u32 v60, v60, v61
    v_and_b32 v61, 3, v61
    v_and_b32 v60, -16, v60
    v_cmp_eq_u32 s[48:49], 2, v61
    v_cmp_ne_u32 s[50:51], 0, v61
    v_cndmask_b32 v60, v6, v60, s[24:25]
    buffer_load_dwordx4 v[46:49], v60, s[4:7], 0 offen
    s_and_b64 s[48:49], s[48:49], s[52:53]
    s_and_b64 s[50:51], s[50:51], s[52:53]
    s_andn2_b64 s[26:27], s[24:25], s[48:49]
    s_andn2_b64 s[28:29], s[24:25], s[50:51]
    s_waitcnt vmcnt(0)
    v_alignbit_b32 v30, v46, v47, 19
    v_lshlrev_b32 v31, 10, v47
    v_and_b32 v30, 0xfff8, v30
    v_lshlrev_b32 v32, 20, v47
    v_alignbit_b32 v31, v48, v31, 19
    v_alignbit_b32 v32, v49, v32, 19
    v_and_b32 v31, 0xfff8, v31
    v_and_b32 v32, 0xfff8, v32
    s_mov_b64 exec, s[24:25]
    ds_read_b64 v[50:51], v30
    s_mov_b64 exec, s[26:27]
    ds_read_b64 v[52:53], v31
    s_mov_b64 exec, s[28:29]
    ds_read_b64 v[54:55], v32
    s_mov_b64 exec, -1
    s_cmp_lg_u32 s37, 0
    s_waitcnt lgkmcnt(0)
    s_cbranch_scc1 k2_wf_slow
    v_and_b32 v12, v6, v46
    v_lshlrev_b32 v42, 16, v50
    v_and_b32 v43, v6, v50
    v_lshlrev_b32 v44, 16, v51
    v_and_b32 v45, v6, v51
    v_fma_f32 v42, v42, v12, v5
    v_fma_f32 v43, v43, v12, v5
    v_fma_f32 v44, v44, v12, v5
    v_fma_f32 v45, v45, v12, v5
    v_and_b32 v12, 0xfff8, v46
    v_lshl_add_u64 v[42:43], v[42:43], 0, s[46:47]
    v_add_u32 v12, 40960, v12
    v_lshl_add_u64 v[44:45], v[44:45], 0, s[46:47]
    s_mov_b64 exec, s[24:25]
    ds_add_u64 v12, v[42:43]
    ds_add_u64 v12, v[44:45] offset:50000
    s_mov_b64 exec, -1
    v_and_b32 v12, v6, v48
    v_lshlrev_b32 v42, 16, v52
    v_and_b32 v43, v6, v52
    v_lshlrev_b32 v44, 16, v53
    v_and_b32 v45, v6, v53
    v_fma_f32 v42, v42, v12, v5
    v_fma_f32 v43, v43, v12, v5
    v_fma_f32 v44, v44, v12, v5
    v_fma_f32 v45, v45, v12, v5
    v_and_b32 v12, 0xfff8, v48
    v_lshl_add_u64 v[42:43], v[42:43], 0, s[46:47]
    v_add_u32 v12, 40960, v12
    v_lshl_add_u64 v[44:45], v[44:45], 0, s[46:47]
    s_mov_b64 exec, s[26:27]
    ds_add_u64 v12, v[42:43]
    ds_add_u64 v12, v[44:45] offset:50000
    s_mov_b64 exec, -1
    v_and_b32 v12, v6, v49
    v_lshlrev_b32 v42, 16, v54
    v_and_b32 v43, v6, v54
    v_lshlrev_b32 v44, 16, v55
    v_and_b32 v45, v6, v55
    v_fma_f32 v42, v42, v12, v5
    v_fma_f32 v43, v43, v12, v5
    v_fma_f32 v44, v44, v12, v5
    v_fma_f32 v45, v45, v12, v5
    v_and_b32 v12, 0xfff8, v49
    v_lshl_add_u64 v[42:43], v[42:43], 0, s[46:47]
    v_add_u32 v12, 40960, v12
    v_lshl_add_u64 v[44:45], v[44:45], 0, s[46:47]
    s_mov_b64 exec, s[28:29]
    ds_add_u64 v12, v[42:43]
    ds_add_u64 v12, v[44:45] offset:50000
    s_mov_b64 exec, -1
    s_branch k2_we_slow
k2_wf_slow:
    v_and_b32 v12, v6, v46
    v_and_b32 v13, 0xfff8, v46
    v_add_u32 v13, 40960, v13
    v_lshlrev_b32 v42, 16, v50
    v_and_b32 v43, v6, v50
    v_lshlrev_b32 v44, 16, v51
    v_and_b32 v45, v6, v51
    v_mul_f32 v42, v42, v12
    v_mul_f32 v43, v43, v12
    v_mul_f32 v44, v44, v12
    v_mul_f32 v45, v45, v12
    s_mov_b64 exec, s[24:25]
    ds_add_f32 v13, v42
    ds_add_f32 v13, v43 offset:4
    ds_add_f32 v13, v44 offset:50000
    ds_add_f32 v13, v45 offset:50004
    s_mov_b64 exec, -1
    s_waitcnt lgkmcnt(0)
    v_and_b32 v12, v6, v48
    v_and_b32 v13, 0xfff8, v48
    v_add_u32 v13, 40960, v13
    v_lshlrev_b32 v42, 16, v52
    v_and_b32 v43, v6, v52
    v_lshlrev_b32 v44, 16, v53
    v_and_b32 v45, v6, v53
    v_mul_f32 v42, v42, v12
    v_mul_f32 v43, v43, v12
    v_mul_f32 v44, v44, v12
    v_mul_f32 v45, v45, v12
    s_mov_b64 exec, s[26:27]
    ds_add_f32 v13, v42
    ds_add_f32 v13, v43 offset:4
    ds_add_f32 v13, v44 offset:50000
    ds_add_f32 v13, v45 offset:50004
    s_mov_b64 exec, -1
    s_waitcnt lgkmcnt(0)
    v_and_b32 v12, v6, v49
    v_and_b32 v13, 0xfff8, v49
    v_add_u32 v13, 40960, v13
    v_lshlrev_b32 v42, 16, v54
    v_and_b32 v43, v6, v54
    v_lshlrev_b32 v44, 16, v55
    v_and_b32 v45, v6, v55
    v_mul_f32 v42, v42, v12
    v_mul_f32 v43, v43, v12
    v_mul_f32 v44, v44, v12
    v_mul_f32 v45, v45, v12
    s_mov_b64 exec, s[28:29]
    ds_add_f32 v13, v42
    ds_add_f32 v13, v43 offset:4
    ds_add_f32 v13, v44 offset:50000
    ds_add_f32 v13, v45 offset:50004
    s_mov_b64 exec, -1
    s_waitcnt lgkmcnt(0)
k2_we_slow:
    s_add_u32 s44, s44, 1024
    s_cmp_lt_u32 s44, s43
    s_cbranch_scc1 k2_slow_l
    s_setpc_b64 s[20:21]
k2_code_end:
    s_endpgm
.section .rodata,"a"
.p2align 6
.amdhsa_kernel k1_kernel
  .amdhsa_next_free_vgpr 128
  .amdhsa_next_free_sgpr 80
  .amdhsa_accum_offset 128
  .amdhsa_group_segment_fixed_size 0
  .amdhsa_kernarg_size 112
  .amdhsa_user_sgpr_count 2
  .amdhsa_user_sgpr_kernarg_segment_ptr 1
  .amdhsa_system_sgpr_workgroup_id_x 1
  .amdhsa_float_denorm_mode_32 3
  .amdhsa_float_denorm_mode_16_64 3
.end_amdhsa_kernel
.section .rodata,"a"
.p2align 6
.amdhsa_kernel k2_kernel
  .amdhsa_next_free_vgpr 128
  .amdhsa_next_free_sgpr 102
  .amdhsa_accum_offset 128
  .amdhsa_group_segment_fixed_size 0
  .amdhsa_kernarg_size 112
  .amdhsa_user_sgpr_count 2
  .amdhsa_user_sgpr_kernarg_segment_ptr 1
  .amdhsa_system_sgpr_workgroup_id_x 1
  .amdhsa_float_denorm_mode_32 3
  .amdhsa_float_denorm_mode_16_64 3
.end_amdhsa_kernel
```
